```python
import torch

def _softmax(x, axis=-1):
    return torch.softmax(x, dim=axis)
def _gelu(x):
    return torch.nn.functional.gelu(x, approximate="tanh")
def _silu(x):
    return torch.nn.functional.silu(x)
def _sigmoid(x):
    return torch.sigmoid(x)
def _layernorm(x, axis=-1, eps=1e-5):
    m = x.mean(dim=axis, keepdim=True)
    v = x.var(dim=axis, keepdim=True, unbiased=False)
    return (x - m) / torch.sqrt(v + eps)
def _scatter_add(tgt, idx, src, axis=0):
    return tgt.clone().index_add_(axis, idx, src)
def _segment_sum(src, seg, n):
    out = torch.zeros((n,) + src.shape[1:], dtype=src.dtype)
    return out.index_add_(0, seg, src)
def _pad(x, pw):
    flat = tuple(v for pair in reversed(pw) for v in pair)
    return torch.nn.functional.pad(x, flat)

kernel_name = 'recurrent_scan__linear_attn_block__mixer_token_mlp__prompt'

def setup_inputs():

    _w = (lambda a: (lambda t: t.to(torch.bfloat16) if t.is_floating_point() else t)(torch.as_tensor(a)))
    def _A_setup():
        B, S, D = 1, 2048, 512
        return {
            "x": _w((lambda *s: torch.randn(*s, dtype=torch.bfloat16) * 0.05)(B, S, D)),
            "wqkv": _w((lambda *s: torch.randn(*s, dtype=torch.bfloat16) * 0.2)(D, 3 * D)),
            "wo": _w((lambda *s: torch.randn(*s, dtype=torch.bfloat16) * 0.2)(D, D)),
        }
    _A_in = _A_setup()

    def _B_setup():
        B, S, D, F = 1, 2048, 512, 1376
        return {
            "x": _w((lambda *s: torch.randn(*s, dtype=torch.bfloat16) * 0.05)(B, S, D)),
            "w1": _w((lambda *s: torch.randn(*s, dtype=torch.bfloat16) * 0.4)(S, F) * (S ** -0.5)),
            "b1": _w((lambda *s: torch.randn(*s, dtype=torch.bfloat16) * 3.2)(F) * 0.02),
            "w2": _w((lambda *s: torch.randn(*s, dtype=torch.bfloat16) * 0.2)(F, S) * (F ** -0.5)),
            "b2": _w((lambda *s: torch.randn(*s, dtype=torch.bfloat16) * 0.4)(S) * 0.02),
        }
    _B_in = _B_setup()

    return {
        "A_x": _A_in["x"],
        "A_wqkv": _A_in["wqkv"],
        "A_wo": _A_in["wo"],
        "B_x": _B_in["x"],
        "B_w1": _B_in["w1"],
        "B_b1": _B_in["b1"],
        "B_w2": _B_in["w2"],
        "B_b2": _B_in["b2"],
    }

def reference(A_x, A_wqkv, A_wo, B_x, B_w1, B_b1, B_w2, B_b2):
    def _A_ref(x, wqkv, wo):
        B, S, D = x.shape
        H = 32; Dh = D // H
        qkv = (lambda x, *d: x.permute(*d))((x @ wqkv).reshape(B, S, 3, H, Dh), 2, 0, 3, 1, 4)
        q, k, v = qkv[0], qkv[1], qkv[2]
        phi = lambda t: torch.where(t > 0, t + 1, torch.exp(t)) + 1e-6
        pq, pk = phi(q), phi(k)
        kv = torch.einsum("bhsd,bhse->bhde", pk, v)
        z = torch.einsum("bhsd->bhd", pk)
        num = torch.einsum("bhqd,bhde->bhqe", pq, kv)
        den = torch.einsum("bhqd,bhd->bhq", pq, z)[..., None] + 1e-6
        o = num / den
        return (lambda x, *d: x.permute(*d))(o, 0, 2, 1, 3).reshape(B, S, D) @ wo

    def _B_ref(x, w1, b1, w2, b2):
        B, S, D = x.shape
        h = _layernorm(x, axis=-1)
        u = torch.einsum("bsd,sf->bdf", h, w1) + b1
        u = _gelu(u)
        y = torch.einsum("bdf,fs->bds", u, w2) + b2
        return (lambda x, *d: x.permute(*d))(y, 0, 2, 1)

    x = A_x
    xn = _layernorm(x, axis=-1)
    s = _A_ref(xn, A_wqkv, A_wo)
    g = _silu(_B_ref(xn, B_w1, B_b1, B_w2, B_b2))
    return x + s * g
```

```asm
; @launch grid=(256,1,1) block=(256,1,1) lds=163840
.amdgcn_target "amdgcn-amd-amdhsa--gfx950"
.text
.globl recurrent_scan__linear_attn_block__mixer_token_mlp__prompt_kernel
.p2align 8
.type recurrent_scan__linear_attn_block__mixer_token_mlp__prompt_kernel,@function
recurrent_scan__linear_attn_block__mixer_token_mlp__prompt_kernel:
    s_cmp_ge_u32 s2, 256
    s_cbranch_scc1 L_end
    s_load_dwordx16 s[4:19], s[0:1], 0
    s_load_dwordx4 s[20:23], s[0:1], 64
    s_load_dwordx2 s[24:25], s[0:1], 80
    s_getpc_b64 s[60:61]
L_pc:
    s_lshr_b32 s59, s2, 3
    v_lshrrev_b32 v2, 5, v0
    s_lshl_b32 s59, s59, 10
    v_lshl_add_u32 v6, v2, 7, s59
    v_min_u32 v6, L_end - L_pc, v6
    global_load_dword v251, v6, s[60:61]
    v_lshrrev_b32 v1, 6, v0
    s_and_b32 s52, s2, 1
    v_readfirstlane_b32 s3, v1
    v_and_b32 v1, 63, v0
    v_lshlrev_b32 v27, 4, v1
    s_bfe_u32 s53, s2, 0x20001
    s_lshr_b32 s54, s2, 3
    s_mov_b32 s59, 0xc9884100
    s_mov_b32 s62, 0xedac6524
    s_bitcmp1_b32 s2, 6
    s_cselect_b32 s59, 0xdb9a5312, s59
    s_cselect_b32 s62, 0xffbe7736, s62
    s_bitcmp1_b32 s2, 7
    s_cselect_b32 s59, s62, s59
    s_and_b32 s62, s2, 7
    s_lshl_b32 s63, s62, 2
    s_lshr_b32 s59, s59, s63
    s_and_b32 s58, s59, 15
    s_and_b32 s57, s54, 7
    s_and_b32 s63, s54, 0x18
    s_add_u32 s62, s62, s63
    s_bitcmp1_b32 0xaaaaaaaa, s62
    s_cbranch_scc0 L_q
    s_mul_i32 s78, s58, 3
    s_lshr_b32 s62, s58, 2
    s_sub_u32 s78, s78, s62
    s_min_u32 s78, s78, 41
    s_bitcmp1_b32 0xc888, s58
    s_cselect_b32 s79, 8, 12
    s_mul_i32 s59, s3, 1409024
    s_lshl_b32 s62, s78, 6
    s_add_u32 s59, s59, s62
    v_mov_b32 v20, 0x7f000000
    v_add_u32 v17, 0, v1
    v_mul_u32_u24 v18, 0x1556, v17
    v_lshrrev_b32 v18, 16, v18
    v_mul_u32_u24 v19, 12, v18
    v_sub_u32 v19, v17, v19
    v_cmp_gt_u32 vcc, s79, v19
    v_mul_u32_u24 v18, 2560, v18
    v_lshl_add_u32 v17, v17, 4, v18
    v_add_u32 v17, s59, v17
    v_cndmask_b32 v14, v20, v17, vcc
    s_sub_u32 s59, s59, 1024
    v_add_u32 v17, 64, v1
    v_mul_u32_u24 v18, 0x1556, v17
    v_lshrrev_b32 v18, 16, v18
    v_mul_u32_u24 v19, 12, v18
    v_sub_u32 v19, v17, v19
    v_cmp_gt_u32 vcc, s79, v19
    v_mul_u32_u24 v18, 2560, v18
    v_lshl_add_u32 v17, v17, 4, v18
    v_add_u32 v17, s59, v17
    v_cndmask_b32 v15, v20, v17, vcc
    s_sub_u32 s59, s59, 1024
    v_add_u32 v17, 128, v1
    v_mul_u32_u24 v18, 0x1556, v17
    v_lshrrev_b32 v18, 16, v18
    v_mul_u32_u24 v19, 12, v18
    v_sub_u32 v19, v17, v19
    v_cmp_gt_u32 vcc, s79, v19
    v_mul_u32_u24 v18, 2560, v18
    v_lshl_add_u32 v17, v17, 4, v18
    v_add_u32 v17, s59, v17
    v_cndmask_b32 v16, v20, v17, vcc
    s_lshr_b32 s63, s2, 6
    s_mul_i32 s63, s63, 0
    s_add_u32 s63, s63, s57
    s_and_b32 s71, s63, 7
    s_mul_i32 s69, s71, 88064
    s_lshl_b32 s72, s71, 15
    s_mov_b32 s73, s72
    s_mul_i32 s70, s3, 40960
    s_waitcnt lgkmcnt(0)
    s_mov_b64 s[36:37], s[12:13]
    s_mov_b32 s38, 0x560000
    s_mov_b32 s39, 0x20000
    s_add_u32 m0, s70, 0
    s_nop 0
    buffer_load_dwordx4 v14, s[36:39], s69 offen offset:0  lds
    buffer_load_dwordx4 v15, s[36:39], s69 offen offset:1024  lds
    buffer_load_dwordx4 v16, s[36:39], s69 offen offset:2048  lds
    s_add_u32 s69, s69, 44032
    s_add_u32 m0, s70, 3072
    s_nop 0
    buffer_load_dwordx4 v14, s[36:39], s69 offen offset:0  lds
    buffer_load_dwordx4 v15, s[36:39], s69 offen offset:1024  lds
    buffer_load_dwordx4 v16, s[36:39], s69 offen offset:2048  lds
    s_add_u32 s64, s71, 1
    s_and_b32 s64, s64, 7
    s_mul_i32 s69, s64, 88064
    s_branch L_u
L_q:
    s_and_b32 s59, s58, 1
    s_lshl3_add_u32 s59, s59, s57
    s_lshr_b32 s57, s58, 1
    s_mov_b32 s58, s59
    s_lshl4_add_u32 s76, s57, s58
    v_lshrrev_b32 v2, 4, v0
    v_and_b32 v3, 15, v0
    v_lshlrev_b32 v3, 4, v3
    v_lshl_add_u32 v5, v2, 10, v3
    s_waitcnt lgkmcnt(0)
    s_mov_b64 s[32:33], s[4:5]
    s_mov_b32 s34, 0x200000
    s_mov_b32 s35, 0x20000
    s_lshl_b32 s59, s76, 14
    buffer_load_dwordx4 v[128:131], v5, s[32:35], s59 offen offset:0
    buffer_load_dwordx4 v[132:135], v5, s[32:35], s59 offen offset:256
    buffer_load_dwordx4 v[136:139], v5, s[32:35], s59 offen offset:512
    buffer_load_dwordx4 v[140:143], v5, s[32:35], s59 offen offset:768
    s_mov_b64 s[36:37], s[6:7]
    s_mov_b32 s38, 0x180000
    s_mov_b32 s39, 0x20000
    v_bfe_u32 v21, v1, 2, 2
    v_and_b32 v22, 3, v1
    v_lshlrev_b32 v22, 7, v22
    v_lshl_add_u32 v21, v21, 10, v22
    v_bfe_u32 v22, v1, 4, 1
    v_mul_u32_u24 v22, 3072, v22
    v_add_u32 v21, v21, v22
    s_and_b32 s62, s58, 7
    s_lshl3_add_u32 s62, s57, s62
    s_lshl2_add_u32 s62, s62, s3
    s_mul_i32 s62, s62, 6144
    s_lshr_b32 s63, s58, 3
    s_lshl_b32 s63, s63, 9
    s_add_u32 s62, s62, s63
    s_mov_b64 exec, 0x0fff0fff
    buffer_load_dword v254, v21, s[36:39], s62 offen
    s_mov_b64 exec, -1
    s_load_dwordx2 s[26:27], s[24:25], 0
    s_mov_b64 s[28:29], s[24:25]
    s_mov_b32 s30, 0x858000
    s_mov_b32 s31, 0x20000
    s_and_b32 s59, s54, 0x1c
    s_lshr_b32 s59, 0x73546210, s59
    s_and_b32 s59, s59, 7
    s_lshl3_add_u32 s55, s53, s59
    s_and_b32 s59, s54, 3
    s_lshl2_add_u32 s56, s52, s59
    v_lshrrev_b32 v2, 4, v0
    v_and_b32 v3, 15, v0
    s_mul_i32 s59, s3, 32768
    s_add_u32 s59, s59, 16384
    v_lshl_add_u32 v4, v2, 11, s59
    v_lshlrev_b32 v6, 1, v2
    v_xor_b32 v6, v6, v3
    v_and_b32 v6, 15, v6
    v_lshl_add_u32 v244, v6, 4, v4
    v_lshlrev_b32 v6, 2, v2
    v_xor_b32 v6, v6, v3
    v_and_b32 v6, 15, v6
    v_lshl_add_u32 v245, v6, 4, v4
    v_lshrrev_b32 v4, 2, v3
    v_lshlrev_b32 v4, 15, v4
    v_lshl_add_u32 v4, v3, 11, v4
    v_add_u32 v4, 16384, v4
    v_lshlrev_b32 v6, 1, v3
    v_xor_b32 v6, v6, v2
    v_and_b32 v6, 15, v6
    v_lshl_add_u32 v246, v6, 4, v4
    v_lshlrev_b32 v3, 4, v3
    v_lshl_add_u32 v247, v2, 9, v3
    v_bfe_u32 v3, v0, 2, 2
    v_bfe_u32 v6, v0, 1, 1
    v_lshl_add_u32 v4, v2, 1, v6
    v_lshlrev_b32 v6, 2, v3
    v_xor_b32 v4, v4, v6
    v_lshlrev_b32 v4, 4, v4
    v_lshl_add_u32 v4, v3, 11, v4
    v_and_b32 v6, 1, v0
    v_lshl_add_u32 v4, v6, 3, v4
    v_add_u32 v248, 17408, v4
    v_add_u32 v249, 81920, v248
    v_lshlrev_b32 v250, 4, v0
    s_lshr_b32 s71, s76, 1
    s_lshl_b32 s71, s71, 15
    s_and_b32 s59, s76, 1
    s_lshl_b32 s59, s59, 8
    s_add_u32 s71, s71, s59
    s_add_u32 s71, s71, 0x100000
    s_lshl_b32 s72, s76, 14
    s_add_u32 s72, s72, 0x300000
    s_lshl2_add_u32 s73, s76, s3
    s_lshl_b32 s73, s73, 7
    s_add_u32 s73, s73, 0x10000
    s_lshl_b32 s74, s3, 7
    s_add_u32 s74, s74, s76
    s_lshl_b32 s74, s74, 7
    s_add_u32 s74, s74, 0x30000
    v_lshrrev_b32 v14, 2, v1
    v_mul_u32_u24 v14, 3072, v14
    v_and_b32 v15, 3, v1
    v_lshl_add_u32 v14, v15, 4, v14
    s_mul_i32 s59, s3, 98304
    s_lshl_b32 s62, s58, 6
    s_add_u32 s59, s59, s62
    v_add_u32 v14, s59, v14
    v_add_u32 v15, 48128, v14
    s_lshl1_add_u32 s69, s58, s57
    v_lshrrev_b32 v16, 5, v1
    v_bfe_u32 v17, v1, 2, 2
    v_lshl_add_u32 v16, v16, 3, v17
    v_lshlrev_b32 v16, 6, v16
    v_bfe_u32 v17, v1, 4, 1
    v_lshl_add_u32 v16, v17, 5, v16
    v_and_b32 v17, 3, v1
    v_lshl_add_u32 v16, v17, 3, v16
    v_add_u32 v17, 81920, v16
    v_add_u32 v22, 24576, v16
    v_add_u32 v23, 81920, v22
    s_lshl2_add_u32 s70, s57, s3
    s_lshl_b32 s59, s70, 11
    s_add_u32 s59, s59, 0x10000
    v_lshrrev_b32 v18, 2, v1
    v_lshlrev_b32 v18, 7, v18
    v_add_u32 v26, s59, v18
    s_mov_b32 s60, 0x3fb8aa3b
    v_mov_b32 v24, 0x358637bd
    v_and_b32 v18, 16, v1
    v_cmp_eq_u32 s[78:79], 0, v18
    s_mul_i32 s59, s3, 40960
    s_add_u32 s59, s59, 32768
    v_add_u32 v18, s59, v27
    s_lshl_b32 s59, s3, 10
    s_add_u32 s59, s59, 32768
    v_add_u32 v19, s59, v27
    v_add_u32 v20, 81920, v19
    s_waitcnt vmcnt(4)
    v_lshlrev_b32 v144, 16, v128
    v_and_b32 v145, 0xffff0000, v128
    v_lshlrev_b32 v146, 16, v129
    v_and_b32 v147, 0xffff0000, v129
    v_lshlrev_b32 v148, 16, v130
    v_and_b32 v149, 0xffff0000, v130
    v_lshlrev_b32 v150, 16, v131
    v_and_b32 v151, 0xffff0000, v131
    v_pk_add_f32 v[176:177], v[144:145], v[146:147]
    v_pk_add_f32 v[178:179], v[148:149], v[150:151]
    s_waitcnt vmcnt(3)
    v_lshlrev_b32 v152, 16, v132
    v_and_b32 v153, 0xffff0000, v132
    v_lshlrev_b32 v154, 16, v133
    v_and_b32 v155, 0xffff0000, v133
    v_lshlrev_b32 v156, 16, v134
    v_and_b32 v157, 0xffff0000, v134
    v_lshlrev_b32 v158, 16, v135
    v_and_b32 v159, 0xffff0000, v135
    v_pk_add_f32 v[176:177], v[176:177], v[152:153]
    v_pk_add_f32 v[178:179], v[178:179], v[154:155]
    v_pk_add_f32 v[176:177], v[176:177], v[156:157]
    v_pk_add_f32 v[178:179], v[178:179], v[158:159]
    s_waitcnt vmcnt(2)
    v_lshlrev_b32 v160, 16, v136
    v_and_b32 v161, 0xffff0000, v136
    v_lshlrev_b32 v162, 16, v137
    v_and_b32 v163, 0xffff0000, v137
    v_lshlrev_b32 v164, 16, v138
    v_and_b32 v165, 0xffff0000, v138
    v_lshlrev_b32 v166, 16, v139
    v_and_b32 v167, 0xffff0000, v139
    v_pk_add_f32 v[176:177], v[176:177], v[160:161]
    v_pk_add_f32 v[178:179], v[178:179], v[162:163]
    v_pk_add_f32 v[176:177], v[176:177], v[164:165]
    v_pk_add_f32 v[178:179], v[178:179], v[166:167]
    s_waitcnt vmcnt(1)
    v_lshlrev_b32 v168, 16, v140
    v_and_b32 v169, 0xffff0000, v140
    v_lshlrev_b32 v170, 16, v141
    v_and_b32 v171, 0xffff0000, v141
    v_lshlrev_b32 v172, 16, v142
    v_and_b32 v173, 0xffff0000, v142
    v_lshlrev_b32 v174, 16, v143
    v_and_b32 v175, 0xffff0000, v143
    v_pk_add_f32 v[176:177], v[176:177], v[168:169]
    v_pk_add_f32 v[178:179], v[178:179], v[170:171]
    v_pk_add_f32 v[176:177], v[176:177], v[172:173]
    v_pk_add_f32 v[178:179], v[178:179], v[174:175]
    v_pk_add_f32 v[176:177], v[176:177], v[178:179]
    v_add_f32 v176, v176, v177
    s_nop 1
    v_add_f32_dpp v176, v176, v176 quad_perm:[1,0,3,2] row_mask:0xf bank_mask:0xf
    s_nop 1
    v_add_f32_dpp v176, v176, v176 quad_perm:[2,3,0,1] row_mask:0xf bank_mask:0xf
    s_nop 1
    v_add_f32_dpp v176, v176, v176 row_half_mirror row_mask:0xf bank_mask:0xf
    s_nop 1
    v_add_f32_dpp v176, v176, v176 row_mirror row_mask:0xf bank_mask:0xf
    v_mul_f32 v180, 0xbb000000, v176
    v_pk_add_f32 v[144:145], v[144:145], v[180:181] op_sel_hi:[1,0]
    v_pk_add_f32 v[146:147], v[146:147], v[180:181] op_sel_hi:[1,0]
    v_pk_add_f32 v[148:149], v[148:149], v[180:181] op_sel_hi:[1,0]
    v_pk_add_f32 v[150:151], v[150:151], v[180:181] op_sel_hi:[1,0]
    v_pk_add_f32 v[152:153], v[152:153], v[180:181] op_sel_hi:[1,0]
    v_pk_add_f32 v[154:155], v[154:155], v[180:181] op_sel_hi:[1,0]
    v_pk_add_f32 v[156:157], v[156:157], v[180:181] op_sel_hi:[1,0]
    v_pk_add_f32 v[158:159], v[158:159], v[180:181] op_sel_hi:[1,0]
    v_pk_add_f32 v[160:161], v[160:161], v[180:181] op_sel_hi:[1,0]
    v_pk_add_f32 v[162:163], v[162:163], v[180:181] op_sel_hi:[1,0]
    v_pk_add_f32 v[164:165], v[164:165], v[180:181] op_sel_hi:[1,0]
    v_pk_add_f32 v[166:167], v[166:167], v[180:181] op_sel_hi:[1,0]
    v_pk_add_f32 v[168:169], v[168:169], v[180:181] op_sel_hi:[1,0]
    v_pk_add_f32 v[170:171], v[170:171], v[180:181] op_sel_hi:[1,0]
    v_pk_add_f32 v[172:173], v[172:173], v[180:181] op_sel_hi:[1,0]
    v_pk_add_f32 v[174:175], v[174:175], v[180:181] op_sel_hi:[1,0]
    v_pk_mul_f32 v[176:177], v[144:145], v[144:145]
    v_pk_mul_f32 v[178:179], v[146:147], v[146:147]
    v_pk_fma_f32 v[176:177], v[148:149], v[148:149], v[176:177]
    v_pk_fma_f32 v[178:179], v[150:151], v[150:151], v[178:179]
    s_add_u32 s68, s69, 0
    s_and_b32 s68, s68, 3
    s_mul_i32 s75, s68, 393216
    s_mul_i32 s68, s68, 20
    s_add_u32 s68, s68, s3
    s_lshl_b32 s68, s68, 11
    s_add_u32 m0, s68, 0
    s_add_u32 s11, s75, 1024
    buffer_load_dwordx4 v14, s[36:39], s11 offen offset:0 lds
    v_pk_fma_f32 v[176:177], v[152:153], v[152:153], v[176:177]
    v_pk_fma_f32 v[178:179], v[154:155], v[154:155], v[178:179]
    v_pk_fma_f32 v[176:177], v[156:157], v[156:157], v[176:177]
    v_pk_fma_f32 v[178:179], v[158:159], v[158:159], v[178:179]
    v_pk_fma_f32 v[176:177], v[160:161], v[160:161], v[176:177]
    v_pk_fma_f32 v[178:179], v[162:163], v[162:163], v[178:179]
    v_pk_fma_f32 v[176:177], v[164:165], v[164:165], v[176:177]
    v_pk_fma_f32 v[178:179], v[166:167], v[166:167], v[178:179]
    v_pk_fma_f32 v[176:177], v[168:169], v[168:169], v[176:177]
    v_pk_fma_f32 v[178:179], v[170:171], v[170:171], v[178:179]
    v_pk_fma_f32 v[176:177], v[172:173], v[172:173], v[176:177]
    v_pk_fma_f32 v[178:179], v[174:175], v[174:175], v[178:179]
    v_pk_add_f32 v[176:177], v[176:177], v[178:179]
    v_add_f32 v176, v176, v177
    v_mov_b32 v182, 0x3727c5ac
    v_mov_b32 v183, 0x3727c5ac
    v_add_f32_dpp v176, v176, v176 quad_perm:[1,0,3,2] row_mask:0xf bank_mask:0xf
    s_nop 1
    v_add_f32_dpp v176, v176, v176 quad_perm:[2,3,0,1] row_mask:0xf bank_mask:0xf
    s_nop 1
    v_add_f32_dpp v176, v176, v176 row_half_mirror row_mask:0xf bank_mask:0xf
    s_nop 1
    v_add_f32_dpp v176, v176, v176 row_mirror row_mask:0xf bank_mask:0xf
    v_fmac_f32 v182, 0x3b000000, v176
    v_rsq_f32 v180, v182
    s_nop 0
    v_pk_mul_f32 v[144:145], v[144:145], v[180:181] op_sel_hi:[1,0]
    v_pk_mul_f32 v[146:147], v[146:147], v[180:181] op_sel_hi:[1,0]
    v_pk_mul_f32 v[148:149], v[148:149], v[180:181] op_sel_hi:[1,0]
    v_pk_mul_f32 v[150:151], v[150:151], v[180:181] op_sel_hi:[1,0]
    v_pk_mul_f32 v[152:153], v[152:153], v[180:181] op_sel_hi:[1,0]
    v_pk_mul_f32 v[154:155], v[154:155], v[180:181] op_sel_hi:[1,0]
    v_pk_mul_f32 v[156:157], v[156:157], v[180:181] op_sel_hi:[1,0]
    v_pk_mul_f32 v[158:159], v[158:159], v[180:181] op_sel_hi:[1,0]
    v_pk_mul_f32 v[160:161], v[160:161], v[180:181] op_sel_hi:[1,0]
    v_pk_mul_f32 v[162:163], v[162:163], v[180:181] op_sel_hi:[1,0]
    v_pk_mul_f32 v[164:165], v[164:165], v[180:181] op_sel_hi:[1,0]
    buffer_load_dwordx4 v15, s[36:39], s11 offen offset:1024 lds
    v_pk_mul_f32 v[166:167], v[166:167], v[180:181] op_sel_hi:[1,0]
    v_pk_mul_f32 v[168:169], v[168:169], v[180:181] op_sel_hi:[1,0]
    v_pk_mul_f32 v[170:171], v[170:171], v[180:181] op_sel_hi:[1,0]
    v_pk_mul_f32 v[172:173], v[172:173], v[180:181] op_sel_hi:[1,0]
    v_pk_mul_f32 v[174:175], v[174:175], v[180:181] op_sel_hi:[1,0]
    v_pk_add_f32 v[176:177], v[144:145], v[146:147]
    v_pk_mul_f32 v[178:179], v[144:145], v[144:145]
    v_pk_fma_f32 v[178:179], v[146:147], v[146:147], v[178:179]
    v_pk_add_f32 v[176:177], v[176:177], v[148:149]
    v_pk_fma_f32 v[178:179], v[148:149], v[148:149], v[178:179]
    v_pk_add_f32 v[176:177], v[176:177], v[150:151]
    v_pk_fma_f32 v[178:179], v[150:151], v[150:151], v[178:179]
    v_pk_add_f32 v[176:177], v[176:177], v[152:153]
    v_pk_fma_f32 v[178:179], v[152:153], v[152:153], v[178:179]
    v_pk_add_f32 v[176:177], v[176:177], v[154:155]
    v_pk_fma_f32 v[178:179], v[154:155], v[154:155], v[178:179]
    v_pk_add_f32 v[176:177], v[176:177], v[156:157]
    v_pk_fma_f32 v[178:179], v[156:157], v[156:157], v[178:179]
    v_pk_add_f32 v[176:177], v[176:177], v[158:159]
    v_pk_fma_f32 v[178:179], v[158:159], v[158:159], v[178:179]
    v_pk_add_f32 v[176:177], v[176:177], v[160:161]
    v_pk_fma_f32 v[178:179], v[160:161], v[160:161], v[178:179]
    v_pk_add_f32 v[176:177], v[176:177], v[162:163]
    v_pk_fma_f32 v[178:179], v[162:163], v[162:163], v[178:179]
    v_pk_add_f32 v[176:177], v[176:177], v[164:165]
    v_pk_fma_f32 v[178:179], v[164:165], v[164:165], v[178:179]
    v_pk_add_f32 v[176:177], v[176:177], v[166:167]
    v_pk_fma_f32 v[178:179], v[166:167], v[166:167], v[178:179]
    v_pk_add_f32 v[176:177], v[176:177], v[168:169]
    v_pk_fma_f32 v[178:179], v[168:169], v[168:169], v[178:179]
    v_pk_add_f32 v[176:177], v[176:177], v[170:171]
    v_pk_fma_f32 v[178:179], v[170:171], v[170:171], v[178:179]
    v_pk_add_f32 v[176:177], v[176:177], v[172:173]
    s_add_u32 m0, s68, 8192
    s_add_u32 s11, s75, 2048
    buffer_load_dwordx4 v14, s[36:39], s11 offen offset:0 lds
    v_pk_fma_f32 v[178:179], v[172:173], v[172:173], v[178:179]
    v_pk_add_f32 v[176:177], v[176:177], v[174:175]
    v_pk_fma_f32 v[178:179], v[174:175], v[174:175], v[178:179]
    v_add_f32 v176, v176, v177
    v_add_f32 v178, v178, v179
    v_cvt_pk_bf16_f32 v128, v144, v145
    v_add_f32_dpp v176, v176, v176 quad_perm:[1,0,3,2] row_mask:0xf bank_mask:0xf
    v_add_f32_dpp v178, v178, v178 quad_perm:[1,0,3,2] row_mask:0xf bank_mask:0xf
    v_cvt_pk_bf16_f32 v129, v146, v147
    v_add_f32_dpp v176, v176, v176 quad_perm:[2,3,0,1] row_mask:0xf bank_mask:0xf
    v_add_f32_dpp v178, v178, v178 quad_perm:[2,3,0,1] row_mask:0xf bank_mask:0xf
    v_cvt_pk_bf16_f32 v130, v148, v149
    v_add_f32_dpp v176, v176, v176 row_half_mirror row_mask:0xf bank_mask:0xf
    v_add_f32_dpp v178, v178, v178 row_half_mirror row_mask:0xf bank_mask:0xf
    v_cvt_pk_bf16_f32 v131, v150, v151
    v_add_f32_dpp v176, v176, v176 row_mirror row_mask:0xf bank_mask:0xf
    v_add_f32_dpp v178, v178, v178 row_mirror row_mask:0xf bank_mask:0xf
    ds_write_b128 v244, v[128:131] offset:0
    v_mul_f32 v176, 0xbb000000, v176
    v_fmac_f32 v183, 0x3b000000, v178
    v_fma_f32 v183, -v176, v176, v183
    v_rsq_f32 v178, v183
    v_cvt_pk_bf16_f32 v132, v152, v153
    v_cvt_pk_bf16_f32 v133, v154, v155
    v_cvt_pk_bf16_f32 v134, v156, v157
    v_cvt_pk_bf16_f32 v135, v158, v159
    ds_write_b128 v244, v[132:135] offset:256
    v_cvt_pk_bf16_f32 v136, v160, v161
    v_cvt_pk_bf16_f32 v137, v162, v163
    v_cvt_pk_bf16_f32 v138, v164, v165
    v_cvt_pk_bf16_f32 v139, v166, v167
    ds_write_b128 v244, v[136:139] offset:512
    v_cvt_pk_bf16_f32 v140, v168, v169
    buffer_load_dwordx4 v15, s[36:39], s11 offen offset:1024 lds
    v_cvt_pk_bf16_f32 v141, v170, v171
    v_cvt_pk_bf16_f32 v142, v172, v173
    v_cvt_pk_bf16_f32 v143, v174, v175
    ds_write_b128 v244, v[140:143] offset:768
    v_mul_f32 v176, v176, v178
    v_pk_fma_f32 v[144:145], v[144:145], v[178:179], v[176:177] op_sel_hi:[1,0,0]
    v_pk_fma_f32 v[146:147], v[146:147], v[178:179], v[176:177] op_sel_hi:[1,0,0]
    v_pk_fma_f32 v[148:149], v[148:149], v[178:179], v[176:177] op_sel_hi:[1,0,0]
    v_pk_fma_f32 v[150:151], v[150:151], v[178:179], v[176:177] op_sel_hi:[1,0,0]
    v_cvt_pk_bf16_f32 v184, v144, v145
    v_cvt_pk_bf16_f32 v185, v146, v147
    v_cvt_pk_bf16_f32 v186, v148, v149
    v_cvt_pk_bf16_f32 v187, v150, v151
    ds_write_b128 v245, v[184:187] offset:1024
    v_pk_fma_f32 v[152:153], v[152:153], v[178:179], v[176:177] op_sel_hi:[1,0,0]
    v_pk_fma_f32 v[154:155], v[154:155], v[178:179], v[176:177] op_sel_hi:[1,0,0]
    v_pk_fma_f32 v[156:157], v[156:157], v[178:179], v[176:177] op_sel_hi:[1,0,0]
    v_pk_fma_f32 v[158:159], v[158:159], v[178:179], v[176:177] op_sel_hi:[1,0,0]
    v_cvt_pk_bf16_f32 v188, v152, v153
    v_cvt_pk_bf16_f32 v189, v154, v155
    v_cvt_pk_bf16_f32 v190, v156, v157
    v_cvt_pk_bf16_f32 v191, v158, v159
    ds_write_b128 v245, v[188:191] offset:1280
    v_pk_fma_f32 v[160:161], v[160:161], v[178:179], v[176:177] op_sel_hi:[1,0,0]
    v_pk_fma_f32 v[162:163], v[162:163], v[178:179], v[176:177] op_sel_hi:[1,0,0]
    v_pk_fma_f32 v[164:165], v[164:165], v[178:179], v[176:177] op_sel_hi:[1,0,0]
    v_pk_fma_f32 v[166:167], v[166:167], v[178:179], v[176:177] op_sel_hi:[1,0,0]
    v_cvt_pk_bf16_f32 v192, v160, v161
    v_cvt_pk_bf16_f32 v193, v162, v163
    v_cvt_pk_bf16_f32 v194, v164, v165
    v_cvt_pk_bf16_f32 v195, v166, v167
    ds_write_b128 v245, v[192:195] offset:1536
    v_pk_fma_f32 v[168:169], v[168:169], v[178:179], v[176:177] op_sel_hi:[1,0,0]
    s_add_u32 m0, s68, 24576
    s_add_u32 s11, s75, 0
    buffer_load_dwordx4 v14, s[36:39], s11 offen offset:0 lds
    v_pk_fma_f32 v[170:171], v[170:171], v[178:179], v[176:177] op_sel_hi:[1,0,0]
    v_pk_fma_f32 v[172:173], v[172:173], v[178:179], v[176:177] op_sel_hi:[1,0,0]
    v_pk_fma_f32 v[174:175], v[174:175], v[178:179], v[176:177] op_sel_hi:[1,0,0]
    v_cvt_pk_bf16_f32 v196, v168, v169
    v_cvt_pk_bf16_f32 v197, v170, v171
    v_cvt_pk_bf16_f32 v198, v172, v173
    v_cvt_pk_bf16_f32 v199, v174, v175
    ds_write_b128 v245, v[196:199] offset:1792
    buffer_load_dwordx4 v15, s[36:39], s11 offen offset:1024 lds
    s_waitcnt lgkmcnt(0)
    s_barrier
    ds_read_b64_tr_b16 v[144:145], v248 offset:0
    ds_read_b64_tr_b16 v[146:147], v248 offset:40960
    ds_read_b64_tr_b16 v[148:149], v248 offset:512
    ds_read_b64_tr_b16 v[150:151], v248 offset:41472
    ds_read_b64_tr_b16 v[152:153], v249 offset:0
    ds_read_b64_tr_b16 v[154:155], v249 offset:40960
    ds_read_b64_tr_b16 v[156:157], v249 offset:512
    ds_read_b64_tr_b16 v[158:159], v249 offset:41472
    ds_read_b128 v[128:131], v246 offset:0
    ds_read_b128 v[132:135], v246 offset:256
    ds_read_b128 v[136:139], v246 offset:512
    ds_read_b128 v[140:143], v246 offset:768
    s_waitcnt lgkmcnt(10)
    buffer_store_dwordx4 v[144:147], v250, s[28:31], s72 offen sc1
    s_add_u32 s72, s72, 4096
    s_waitcnt lgkmcnt(8)
    buffer_store_dwordx4 v[148:151], v250, s[28:31], s72 offen sc1
    s_add_u32 s72, s72, 4096
    s_waitcnt lgkmcnt(6)
    buffer_store_dwordx4 v[152:155], v250, s[28:31], s72 offen sc1
    s_add_u32 s72, s72, 4096
    s_waitcnt lgkmcnt(4)
    buffer_store_dwordx4 v[156:159], v250, s[28:31], s72 offen sc1
    s_waitcnt lgkmcnt(3)
    buffer_store_dwordx4 v[128:131], v247, s[28:31], s71 offen sc1
    s_add_u32 s71, s71, 8192
    s_waitcnt lgkmcnt(2)
    buffer_store_dwordx4 v[132:135], v247, s[28:31], s71 offen sc1
    s_add_u32 s71, s71, 8192
    s_waitcnt lgkmcnt(1)
    buffer_store_dwordx4 v[136:139], v247, s[28:31], s71 offen sc1
    s_add_u32 s71, s71, 8192
    s_waitcnt lgkmcnt(0)
    buffer_store_dwordx4 v[140:143], v247, s[28:31], s71 offen sc1
    s_add_u32 s26, s26, 0x9e3779b9
    s_addc_u32 s27, s27, 0x7f4a7c15
    v_mov_b32 v28, s26
    v_mov_b32 v29, s27
    s_add_u32 s68, s69, 1
    s_and_b32 s68, s68, 3
    s_mul_i32 s75, s68, 393216
    s_mul_i32 s68, s68, 20
    s_add_u32 s68, s68, s3
    s_lshl_b32 s68, s68, 11
    s_add_u32 m0, s68, 0
    s_add_u32 s11, s75, 1024
    buffer_load_dwordx4 v14, s[36:39], s11 offen offset:0 lds
    buffer_load_dwordx4 v15, s[36:39], s11 offen offset:1024 lds
    s_waitcnt vmcnt(6)
    s_mov_b64 exec, 1
    buffer_store_dwordx2 v[28:29], off, s[28:31], s74 sc1
    s_mov_b64 exec, -1
    s_waitcnt vmcnt(3)
    s_mov_b64 exec, 1
    buffer_store_dwordx2 v[28:29], off, s[28:31], s73 sc1
    s_mov_b64 exec, -1
    s_add_u32 m0, s68, 8192
    s_add_u32 s11, s75, 2048
    buffer_load_dwordx4 v14, s[36:39], s11 offen offset:0 lds
    buffer_load_dwordx4 v15, s[36:39], s11 offen offset:1024 lds
    s_add_u32 m0, s68, 24576
    s_add_u32 s11, s75, 0
    buffer_load_dwordx4 v14, s[36:39], s11 offen offset:0 lds
    buffer_load_dwordx4 v15, s[36:39], s11 offen offset:1024 lds
    s_add_u32 s68, s69, 2
    s_and_b32 s68, s68, 3
    s_mul_i32 s75, s68, 393216
    s_mul_i32 s68, s68, 20
    s_add_u32 s68, s68, s3
    s_lshl_b32 s68, s68, 11
    s_add_u32 m0, s68, 0
    s_add_u32 s11, s75, 1024
    buffer_load_dwordx4 v14, s[36:39], s11 offen offset:0 lds
    buffer_load_dwordx4 v15, s[36:39], s11 offen offset:1024 lds
    s_add_u32 m0, s68, 8192
    s_add_u32 s11, s75, 2048
    buffer_load_dwordx4 v14, s[36:39], s11 offen offset:0 lds
    buffer_load_dwordx4 v15, s[36:39], s11 offen offset:1024 lds
    s_add_u32 m0, s68, 24576
    s_add_u32 s11, s75, 0
    buffer_load_dwordx4 v14, s[36:39], s11 offen offset:0 lds
    buffer_load_dwordx4 v15, s[36:39], s11 offen offset:1024 lds
    s_add_u32 s68, s69, 3
    s_and_b32 s68, s68, 3
    s_mul_i32 s75, s68, 393216
    s_mul_i32 s68, s68, 20
    s_add_u32 s68, s68, s3
    s_lshl_b32 s68, s68, 11
    s_add_u32 m0, s68, 0
    s_add_u32 s11, s75, 1024
    buffer_load_dwordx4 v14, s[36:39], s11 offen offset:0 lds
    buffer_load_dwordx4 v15, s[36:39], s11 offen offset:1024 lds
    s_add_u32 m0, s68, 8192
    s_add_u32 s11, s75, 2048
    buffer_load_dwordx4 v14, s[36:39], s11 offen offset:0 lds
    buffer_load_dwordx4 v15, s[36:39], s11 offen offset:1024 lds
    s_add_u32 m0, s68, 24576
    s_add_u32 s11, s75, 0
    buffer_load_dwordx4 v14, s[36:39], s11 offen offset:0 lds
    buffer_load_dwordx4 v15, s[36:39], s11 offen offset:1024 lds
    s_mov_b64 s[40:41], s[16:17]
    s_mov_b32 s42, 0x560000
    s_mov_b32 s43, 0x20000
    s_mov_b64 s[44:45], s[8:9]
    s_mov_b32 s46, 0x80000
    s_mov_b32 s47, 0x20000
    v_lshrrev_b32 v10, 3, v1
    v_bfe_u32 v11, v1, 4, 1
    v_lshlrev_b32 v11, 2, v11
    v_and_b32 v12, 7, v1
    v_xor_b32 v11, v11, v12
    v_lshlrev_b32 v11, 4, v11
    v_lshl_add_u32 v2, v10, 12, v11
    v_lshl_add_u32 v6, v10, 10, v11
    v_add_u32 v3, 31744, v2
    v_add_u32 v7, 7168, v6
    v_add_u32 v4, 31744, v3
    v_add_u32 v8, 7168, v7
    v_add_u32 v5, 31744, v4
    v_add_u32 v9, 7168, v8
    s_mul_i32 s65, s3, 1441792
    s_lshl_b32 s59, s55, 7
    s_add_u32 s65, s65, s59
    s_and_b32 s10, s56, 3
    s_mul_i32 s10, s10, 3
    s_lshl_b32 s59, s10, 17
    s_add_u32 s65, s65, s59
    s_lshl_b32 s66, s3, 17
    s_lshl_b32 s59, s56, 7
    s_add_u32 s66, s66, s59
    s_mul_i32 s67, s3, 40960
    v_lshrrev_b32 v10, 5, v1
    v_bfe_u32 v11, v1, 2, 2
    v_lshl_add_u32 v10, v10, 2, v11
    v_lshlrev_b32 v10, 7, v10
    v_bfe_u32 v11, v1, 3, 1
    v_lshl_add_u32 v10, v11, 6, v10
    v_bfe_u32 v11, v1, 4, 1
    v_lshl_add_u32 v10, v11, 5, v10
    v_and_b32 v11, 3, v1
    v_lshl_add_u32 v10, v11, 3, v10
    s_lshr_b32 s59, s3, 1
    s_mul_i32 s59, s59, 81920
    s_add_u32 s59, s59, 24576
    v_add_u32 v12, s59, v10
    v_xor_b32 v13, 64, v12
    v_add_u32 v10, s67, v10
    v_xor_b32 v11, 64, v10
    s_lshl_b32 s71, s70, 16
    s_add_u32 s71, s71, 0x100000
    buffer_load_dwordx2 v[30:31], v26, s[28:31], 0 offen sc1
    s_waitcnt vmcnt(1)
    s_barrier
    s_waitcnt vmcnt(0)
    v_cmp_ne_u64 vcc, s[26:27], v[30:31]
    s_nop 0
    s_cbranch_vccz L_ok0
    s_mov_b32 s77, 0
L_spin0:
    s_sleep 1
    buffer_load_dwordx2 v[30:31], v26, s[28:31], 0 offen sc1
    s_add_u32 s77, s77, 1
    s_cmp_ge_u32 s77, 0x10000
    s_waitcnt vmcnt(0)
    s_cbranch_scc1 L_ok0
    v_cmp_ne_u64 vcc, s[26:27], v[30:31]
    s_nop 0
    s_cbranch_vccnz L_spin0
L_ok0:
    buffer_load_dwordx4 a[0:3], v27, s[28:31], s71 offen offset:0 sc1
    buffer_load_dwordx4 a[4:7], v27, s[28:31], s71 offen offset:1024 sc1
    buffer_load_dwordx4 a[8:11], v27, s[28:31], s71 offen offset:2048 sc1
    buffer_load_dwordx4 a[12:15], v27, s[28:31], s71 offen offset:3072 sc1
    s_add_u32 s71, s71, 4096
    buffer_load_dwordx4 a[16:19], v27, s[28:31], s71 offen offset:0 sc1
    buffer_load_dwordx4 a[20:23], v27, s[28:31], s71 offen offset:1024 sc1
    buffer_load_dwordx4 a[24:27], v27, s[28:31], s71 offen offset:2048 sc1
    buffer_load_dwordx4 a[28:31], v27, s[28:31], s71 offen offset:3072 sc1
    s_add_u32 s71, s71, 4096
    ds_read_b64_tr_b16 v[128:129], v16 offset:0
    ds_read_b64_tr_b16 v[130:131], v16 offset:256
    ds_read_b64_tr_b16 v[132:133], v16 offset:8192
    ds_read_b64_tr_b16 v[134:135], v16 offset:8448
    ds_read_b64_tr_b16 v[136:137], v22 offset:0
    ds_read_b64_tr_b16 v[138:139], v22 offset:256
    ds_read_b64_tr_b16 v[140:141], v16 offset:1024
    ds_read_b64_tr_b16 v[142:143], v16 offset:1280
    ds_read_b64_tr_b16 v[144:145], v16 offset:9216
    ds_read_b64_tr_b16 v[146:147], v16 offset:9472
    ds_read_b64_tr_b16 v[148:149], v22 offset:1024
    ds_read_b64_tr_b16 v[150:151], v22 offset:1280
    s_waitcnt vmcnt(7) lgkmcnt(10)
    v_mfma_f32_32x32x16_bf16 v[32:47], a[0:3], v[128:131], 0
    buffer_load_dwordx4 a[32:35], v27, s[28:31], s71 offen offset:0 sc1
    ds_read_b64_tr_b16 v[152:153], v16 offset:2048
    ds_read_b64_tr_b16 v[154:155], v16 offset:2304
    s_waitcnt lgkmcnt(10)
    v_mfma_f32_32x32x16_bf16 v[64:79], a[0:3], v[132:135], 0
    ds_read_b64_tr_b16 v[156:157], v16 offset:10240
    ds_read_b64_tr_b16 v[158:159], v16 offset:10496
    s_waitcnt lgkmcnt(10)
    v_mfma_f32_32x32x16_bf16 v[96:111], v[136:139], a[0:3], 0
    ds_read_b64_tr_b16 v[160:161], v22 offset:2048
    ds_read_b64_tr_b16 v[162:163], v22 offset:2304
    s_waitcnt vmcnt(7) lgkmcnt(10)
    v_mfma_f32_32x32x16_bf16 v[32:47], a[4:7], v[140:143], v[32:47]
    buffer_load_dwordx4 a[36:39], v27, s[28:31], s71 offen offset:1024 sc1
    ds_read_b64_tr_b16 v[164:165], v16 offset:3072
    ds_read_b64_tr_b16 v[166:167], v16 offset:3328
    s_waitcnt lgkmcnt(10)
    v_mfma_f32_32x32x16_bf16 v[64:79], a[4:7], v[144:147], v[64:79]
    ds_read_b64_tr_b16 v[168:169], v16 offset:11264
    ds_read_b64_tr_b16 v[170:171], v16 offset:11520
    s_waitcnt lgkmcnt(10)
    v_mfma_f32_32x32x16_bf16 v[96:111], v[148:151], a[4:7], v[96:111]
    ds_read_b64_tr_b16 v[172:173], v22 offset:3072
    ds_read_b64_tr_b16 v[174:175], v22 offset:3328
    s_waitcnt vmcnt(7) lgkmcnt(10)
    v_mfma_f32_32x32x16_bf16 v[32:47], a[8:11], v[152:155], v[32:47]
    buffer_load_dwordx4 a[40:43], v27, s[28:31], s71 offen offset:2048 sc1
    buffer_load_dwordx4 a[44:47], v27, s[28:31], s71 offen offset:3072 sc1
    s_add_u32 s71, s71, 4096
    ds_read_b64_tr_b16 v[128:129], v16 offset:4096
    s_waitcnt lgkmcnt(9)
    v_mfma_f32_32x32x16_bf16 v[64:79], a[8:11], v[156:159], v[64:79]
    ds_read_b64_tr_b16 v[130:131], v16 offset:4352
    ds_read_b64_tr_b16 v[132:133], v16 offset:12288
    ds_read_b64_tr_b16 v[134:135], v16 offset:12544
    s_waitcnt lgkmcnt(10)
    v_mfma_f32_32x32x16_bf16 v[96:111], v[160:163], a[8:11], v[96:111]
    ds_read_b64_tr_b16 v[136:137], v22 offset:4096
    ds_read_b64_tr_b16 v[138:139], v22 offset:4352
    s_waitcnt vmcnt(8) lgkmcnt(10)
    v_mfma_f32_32x32x16_bf16 v[32:47], a[12:15], v[164:167], v[32:47]
    buffer_load_dwordx4 a[48:51], v27, s[28:31], s71 offen offset:0 sc1
    ds_read_b64_tr_b16 v[140:141], v16 offset:5120
    ds_read_b64_tr_b16 v[142:143], v16 offset:5376
    s_waitcnt lgkmcnt(10)
    v_mfma_f32_32x32x16_bf16 v[64:79], a[12:15], v[168:171], v[64:79]
    ds_read_b64_tr_b16 v[144:145], v16 offset:13312
    ds_read_b64_tr_b16 v[146:147], v16 offset:13568
    s_waitcnt lgkmcnt(10)
    v_mfma_f32_32x32x16_bf16 v[96:111], v[172:175], a[12:15], v[96:111]
    ds_read_b64_tr_b16 v[148:149], v22 offset:5120
    ds_read_b64_tr_b16 v[150:151], v22 offset:5376
    s_waitcnt vmcnt(8) lgkmcnt(10)
    v_mfma_f32_32x32x16_bf16 v[32:47], a[16:19], v[128:131], v[32:47]
    buffer_load_dwordx4 a[52:55], v27, s[28:31], s71 offen offset:1024 sc1
    ds_read_b64_tr_b16 v[152:153], v16 offset:6144
    ds_read_b64_tr_b16 v[154:155], v16 offset:6400
    s_waitcnt lgkmcnt(10)
    v_mfma_f32_32x32x16_bf16 v[64:79], a[16:19], v[132:135], v[64:79]
    ds_read_b64_tr_b16 v[156:157], v16 offset:14336
    ds_read_b64_tr_b16 v[158:159], v16 offset:14592
    s_waitcnt lgkmcnt(10)
    v_mfma_f32_32x32x16_bf16 v[96:111], v[136:139], a[16:19], v[96:111]
    ds_read_b64_tr_b16 v[160:161], v22 offset:6144
    ds_read_b64_tr_b16 v[162:163], v22 offset:6400
    s_waitcnt vmcnt(8) lgkmcnt(10)
    v_mfma_f32_32x32x16_bf16 v[32:47], a[20:23], v[140:143], v[32:47]
    buffer_load_dwordx4 a[56:59], v27, s[28:31], s71 offen offset:2048 sc1
    buffer_load_dwordx4 a[60:63], v27, s[28:31], s71 offen offset:3072 sc1
    s_add_u32 s71, s71, 4096
    ds_read_b64_tr_b16 v[164:165], v16 offset:7168
    s_waitcnt lgkmcnt(9)
    v_mfma_f32_32x32x16_bf16 v[64:79], a[20:23], v[144:147], v[64:79]
    ds_read_b64_tr_b16 v[166:167], v16 offset:7424
    ds_read_b64_tr_b16 v[168:169], v16 offset:15360
    ds_read_b64_tr_b16 v[170:171], v16 offset:15616
    s_waitcnt lgkmcnt(10)
    v_mfma_f32_32x32x16_bf16 v[96:111], v[148:151], a[20:23], v[96:111]
    ds_read_b64_tr_b16 v[172:173], v22 offset:7168
    ds_read_b64_tr_b16 v[174:175], v22 offset:7424
    s_waitcnt vmcnt(9) lgkmcnt(10)
    v_mfma_f32_32x32x16_bf16 v[32:47], a[24:27], v[152:155], v[32:47]
    buffer_load_dwordx4 a[64:67], v27, s[28:31], s71 offen offset:0 sc1
    ds_read_b64_tr_b16 v[128:129], v16 offset:40960
    ds_read_b64_tr_b16 v[130:131], v16 offset:41216
    s_waitcnt lgkmcnt(10)
    v_mfma_f32_32x32x16_bf16 v[64:79], a[24:27], v[156:159], v[64:79]
    ds_read_b64_tr_b16 v[132:133], v16 offset:49152
    ds_read_b64_tr_b16 v[134:135], v16 offset:49408
    s_waitcnt lgkmcnt(10)
    v_mfma_f32_32x32x16_bf16 v[96:111], v[160:163], a[24:27], v[96:111]
    ds_read_b64_tr_b16 v[136:137], v22 offset:40960
    ds_read_b64_tr_b16 v[138:139], v22 offset:41216
    s_waitcnt vmcnt(9) lgkmcnt(10)
    v_mfma_f32_32x32x16_bf16 v[32:47], a[28:31], v[164:167], v[32:47]
    buffer_load_dwordx4 a[68:71], v27, s[28:31], s71 offen offset:1024 sc1
    ds_read_b64_tr_b16 v[140:141], v16 offset:41984
    ds_read_b64_tr_b16 v[142:143], v16 offset:42240
    s_waitcnt lgkmcnt(10)
    v_mfma_f32_32x32x16_bf16 v[64:79], a[28:31], v[168:171], v[64:79]
    ds_read_b64_tr_b16 v[144:145], v16 offset:50176
    ds_read_b64_tr_b16 v[146:147], v16 offset:50432
    s_waitcnt lgkmcnt(10)
    v_mfma_f32_32x32x16_bf16 v[96:111], v[172:175], a[28:31], v[96:111]
    ds_read_b64_tr_b16 v[148:149], v22 offset:41984
    ds_read_b64_tr_b16 v[150:151], v22 offset:42240
    s_waitcnt vmcnt(9) lgkmcnt(10)
    v_mfma_f32_32x32x16_bf16 v[32:47], a[32:35], v[128:131], v[32:47]
    buffer_load_dwordx4 a[72:75], v27, s[28:31], s71 offen offset:2048 sc1
    buffer_load_dwordx4 a[76:79], v27, s[28:31], s71 offen offset:3072 sc1
    s_add_u32 s71, s71, 4096
    ds_read_b64_tr_b16 v[152:153], v16 offset:43008
    s_waitcnt lgkmcnt(9)
    v_mfma_f32_32x32x16_bf16 v[64:79], a[32:35], v[132:135], v[64:79]
    ds_read_b64_tr_b16 v[154:155], v16 offset:43264
    ds_read_b64_tr_b16 v[156:157], v16 offset:51200
    ds_read_b64_tr_b16 v[158:159], v16 offset:51456
    s_waitcnt lgkmcnt(10)
    v_mfma_f32_32x32x16_bf16 v[96:111], v[136:139], a[32:35], v[96:111]
    ds_read_b64_tr_b16 v[160:161], v22 offset:43008
    ds_read_b64_tr_b16 v[162:163], v22 offset:43264
    s_waitcnt vmcnt(10) lgkmcnt(10)
    v_mfma_f32_32x32x16_bf16 v[32:47], a[36:39], v[140:143], v[32:47]
    buffer_load_dwordx4 a[80:83], v27, s[28:31], s71 offen offset:0 sc1
    ds_read_b64_tr_b16 v[164:165], v16 offset:44032
    ds_read_b64_tr_b16 v[166:167], v16 offset:44288
    s_waitcnt lgkmcnt(10)
    v_mfma_f32_32x32x16_bf16 v[64:79], a[36:39], v[144:147], v[64:79]
    ds_read_b64_tr_b16 v[168:169], v16 offset:52224
    ds_read_b64_tr_b16 v[170:171], v16 offset:52480
    s_waitcnt lgkmcnt(10)
    v_mfma_f32_32x32x16_bf16 v[96:111], v[148:151], a[36:39], v[96:111]
    ds_read_b64_tr_b16 v[172:173], v22 offset:44032
    ds_read_b64_tr_b16 v[174:175], v22 offset:44288
    s_waitcnt vmcnt(10) lgkmcnt(10)
    v_mfma_f32_32x32x16_bf16 v[32:47], a[40:43], v[152:155], v[32:47]
    buffer_load_dwordx4 a[84:87], v27, s[28:31], s71 offen offset:1024 sc1
    ds_read_b64_tr_b16 v[128:129], v16 offset:45056
    ds_read_b64_tr_b16 v[130:131], v16 offset:45312
    s_waitcnt lgkmcnt(10)
    v_mfma_f32_32x32x16_bf16 v[64:79], a[40:43], v[156:159], v[64:79]
    ds_read_b64_tr_b16 v[132:133], v16 offset:53248
    ds_read_b64_tr_b16 v[134:135], v16 offset:53504
    s_waitcnt lgkmcnt(10)
    v_mfma_f32_32x32x16_bf16 v[96:111], v[160:163], a[40:43], v[96:111]
    ds_read_b64_tr_b16 v[136:137], v22 offset:45056
    ds_read_b64_tr_b16 v[138:139], v22 offset:45312
    s_waitcnt vmcnt(10) lgkmcnt(10)
    v_mfma_f32_32x32x16_bf16 v[32:47], a[44:47], v[164:167], v[32:47]
    buffer_load_dwordx4 a[88:91], v27, s[28:31], s71 offen offset:2048 sc1
    buffer_load_dwordx4 a[92:95], v27, s[28:31], s71 offen offset:3072 sc1
    s_add_u32 s71, s71, 4096
    ds_read_b64_tr_b16 v[140:141], v16 offset:46080
    s_waitcnt lgkmcnt(9)
    v_mfma_f32_32x32x16_bf16 v[64:79], a[44:47], v[168:171], v[64:79]
    ds_read_b64_tr_b16 v[142:143], v16 offset:46336
    ds_read_b64_tr_b16 v[144:145], v16 offset:54272
    ds_read_b64_tr_b16 v[146:147], v16 offset:54528
    s_waitcnt lgkmcnt(10)
    v_mfma_f32_32x32x16_bf16 v[96:111], v[172:175], a[44:47], v[96:111]
    ds_read_b64_tr_b16 v[148:149], v22 offset:46080
    ds_read_b64_tr_b16 v[150:151], v22 offset:46336
    s_waitcnt vmcnt(11) lgkmcnt(10)
    v_mfma_f32_32x32x16_bf16 v[32:47], a[48:51], v[128:131], v[32:47]
    buffer_load_dwordx4 a[96:99], v27, s[28:31], s71 offen offset:0 sc1
    ds_read_b64_tr_b16 v[152:153], v16 offset:47104
    ds_read_b64_tr_b16 v[154:155], v16 offset:47360
    s_waitcnt lgkmcnt(10)
    v_mfma_f32_32x32x16_bf16 v[64:79], a[48:51], v[132:135], v[64:79]
    ds_read_b64_tr_b16 v[156:157], v16 offset:55296
    ds_read_b64_tr_b16 v[158:159], v16 offset:55552
    s_waitcnt lgkmcnt(10)
    v_mfma_f32_32x32x16_bf16 v[96:111], v[136:139], a[48:51], v[96:111]
    ds_read_b64_tr_b16 v[160:161], v22 offset:47104
    ds_read_b64_tr_b16 v[162:163], v22 offset:47360
    s_waitcnt vmcnt(11) lgkmcnt(10)
    v_mfma_f32_32x32x16_bf16 v[32:47], a[52:55], v[140:143], v[32:47]
    buffer_load_dwordx4 a[100:103], v27, s[28:31], s71 offen offset:1024 sc1
    ds_read_b64_tr_b16 v[164:165], v16 offset:48128
    ds_read_b64_tr_b16 v[166:167], v16 offset:48384
    s_waitcnt lgkmcnt(10)
    v_mfma_f32_32x32x16_bf16 v[64:79], a[52:55], v[144:147], v[64:79]
    ds_read_b64_tr_b16 v[168:169], v16 offset:56320
    ds_read_b64_tr_b16 v[170:171], v16 offset:56576
    s_waitcnt lgkmcnt(10)
    v_mfma_f32_32x32x16_bf16 v[96:111], v[148:151], a[52:55], v[96:111]
    ds_read_b64_tr_b16 v[172:173], v22 offset:48128
    ds_read_b64_tr_b16 v[174:175], v22 offset:48384
    s_waitcnt vmcnt(11) lgkmcnt(10)
    v_mfma_f32_32x32x16_bf16 v[32:47], a[56:59], v[152:155], v[32:47]
    buffer_load_dwordx4 a[104:107], v27, s[28:31], s71 offen offset:2048 sc1
    buffer_load_dwordx4 a[108:111], v27, s[28:31], s71 offen offset:3072 sc1
    s_add_u32 s71, s71, 4096
    ds_read_b64_tr_b16 v[128:129], v17 offset:0
    s_waitcnt lgkmcnt(9)
    v_mfma_f32_32x32x16_bf16 v[64:79], a[56:59], v[156:159], v[64:79]
    ds_read_b64_tr_b16 v[130:131], v17 offset:256
    ds_read_b64_tr_b16 v[132:133], v17 offset:8192
    ds_read_b64_tr_b16 v[134:135], v17 offset:8448
    s_waitcnt lgkmcnt(10)
    v_mfma_f32_32x32x16_bf16 v[96:111], v[160:163], a[56:59], v[96:111]
    ds_read_b64_tr_b16 v[136:137], v23 offset:0
    ds_read_b64_tr_b16 v[138:139], v23 offset:256
    s_waitcnt vmcnt(12) lgkmcnt(10)
    v_mfma_f32_32x32x16_bf16 v[32:47], a[60:63], v[164:167], v[32:47]
    buffer_load_dwordx4 a[112:115], v27, s[28:31], s71 offen offset:0 sc1
    ds_read_b64_tr_b16 v[140:141], v17 offset:1024
    ds_read_b64_tr_b16 v[142:143], v17 offset:1280
    s_waitcnt lgkmcnt(10)
    v_mfma_f32_32x32x16_bf16 v[64:79], a[60:63], v[168:171], v[64:79]
    ds_read_b64_tr_b16 v[144:145], v17 offset:9216
    ds_read_b64_tr_b16 v[146:147], v17 offset:9472
    s_waitcnt lgkmcnt(10)
    v_mfma_f32_32x32x16_bf16 v[96:111], v[172:175], a[60:63], v[96:111]
    ds_read_b64_tr_b16 v[148:149], v23 offset:1024
    ds_read_b64_tr_b16 v[150:151], v23 offset:1280
    s_waitcnt vmcnt(12) lgkmcnt(10)
    v_mfma_f32_32x32x16_bf16 v[32:47], a[64:67], v[128:131], v[32:47]
    buffer_load_dwordx4 a[116:119], v27, s[28:31], s71 offen offset:1024 sc1
    ds_read_b64_tr_b16 v[152:153], v17 offset:2048
    ds_read_b64_tr_b16 v[154:155], v17 offset:2304
    s_waitcnt lgkmcnt(10)
    v_mfma_f32_32x32x16_bf16 v[64:79], a[64:67], v[132:135], v[64:79]
    ds_read_b64_tr_b16 v[156:157], v17 offset:10240
    ds_read_b64_tr_b16 v[158:159], v17 offset:10496
    s_waitcnt lgkmcnt(10)
    v_mfma_f32_32x32x16_bf16 v[96:111], v[136:139], a[64:67], v[96:111]
    ds_read_b64_tr_b16 v[160:161], v23 offset:2048
    ds_read_b64_tr_b16 v[162:163], v23 offset:2304
    s_waitcnt vmcnt(12) lgkmcnt(10)
    v_mfma_f32_32x32x16_bf16 v[32:47], a[68:71], v[140:143], v[32:47]
    buffer_load_dwordx4 a[120:123], v27, s[28:31], s71 offen offset:2048 sc1
    buffer_load_dwordx4 a[124:127], v27, s[28:31], s71 offen offset:3072 sc1
    s_add_u32 s71, s71, 4096
    ds_read_b64_tr_b16 v[164:165], v17 offset:3072
    s_waitcnt lgkmcnt(9)
    v_mfma_f32_32x32x16_bf16 v[64:79], a[68:71], v[144:147], v[64:79]
    ds_read_b64_tr_b16 v[166:167], v17 offset:3328
    ds_read_b64_tr_b16 v[168:169], v17 offset:11264
    ds_read_b64_tr_b16 v[170:171], v17 offset:11520
    s_waitcnt lgkmcnt(10)
    v_mfma_f32_32x32x16_bf16 v[96:111], v[148:151], a[68:71], v[96:111]
    ds_read_b64_tr_b16 v[172:173], v23 offset:3072
    ds_read_b64_tr_b16 v[174:175], v23 offset:3328
    s_waitcnt vmcnt(13) lgkmcnt(10)
    v_mfma_f32_32x32x16_bf16 v[32:47], a[72:75], v[152:155], v[32:47]
    buffer_load_dwordx4 a[128:131], v27, s[28:31], s71 offen offset:0 sc1
    ds_read_b64_tr_b16 v[128:129], v17 offset:4096
    ds_read_b64_tr_b16 v[130:131], v17 offset:4352
    s_waitcnt lgkmcnt(10)
    v_mfma_f32_32x32x16_bf16 v[64:79], a[72:75], v[156:159], v[64:79]
    ds_read_b64_tr_b16 v[132:133], v17 offset:12288
    ds_read_b64_tr_b16 v[134:135], v17 offset:12544
    s_waitcnt lgkmcnt(10)
    v_mfma_f32_32x32x16_bf16 v[96:111], v[160:163], a[72:75], v[96:111]
    ds_read_b64_tr_b16 v[136:137], v23 offset:4096
    ds_read_b64_tr_b16 v[138:139], v23 offset:4352
    s_waitcnt vmcnt(13) lgkmcnt(10)
    v_mfma_f32_32x32x16_bf16 v[32:47], a[76:79], v[164:167], v[32:47]
    buffer_load_dwordx4 a[132:135], v27, s[28:31], s71 offen offset:1024 sc1
    ds_read_b64_tr_b16 v[140:141], v17 offset:5120
    ds_read_b64_tr_b16 v[142:143], v17 offset:5376
    s_waitcnt lgkmcnt(10)
    v_mfma_f32_32x32x16_bf16 v[64:79], a[76:79], v[168:171], v[64:79]
    ds_read_b64_tr_b16 v[144:145], v17 offset:13312
    ds_read_b64_tr_b16 v[146:147], v17 offset:13568
    s_waitcnt lgkmcnt(10)
    v_mfma_f32_32x32x16_bf16 v[96:111], v[172:175], a[76:79], v[96:111]
    ds_read_b64_tr_b16 v[148:149], v23 offset:5120
    ds_read_b64_tr_b16 v[150:151], v23 offset:5376
    s_waitcnt vmcnt(13) lgkmcnt(10)
    v_mfma_f32_32x32x16_bf16 v[32:47], a[80:83], v[128:131], v[32:47]
    buffer_load_dwordx4 a[136:139], v27, s[28:31], s71 offen offset:2048 sc1
    buffer_load_dwordx4 a[140:143], v27, s[28:31], s71 offen offset:3072 sc1
    s_add_u32 s71, s71, 4096
    ds_read_b64_tr_b16 v[152:153], v17 offset:6144
    s_waitcnt lgkmcnt(9)
    v_mfma_f32_32x32x16_bf16 v[64:79], a[80:83], v[132:135], v[64:79]
    ds_read_b64_tr_b16 v[154:155], v17 offset:6400
    ds_read_b64_tr_b16 v[156:157], v17 offset:14336
    ds_read_b64_tr_b16 v[158:159], v17 offset:14592
    s_waitcnt lgkmcnt(10)
    v_mfma_f32_32x32x16_bf16 v[96:111], v[136:139], a[80:83], v[96:111]
    ds_read_b64_tr_b16 v[160:161], v23 offset:6144
    ds_read_b64_tr_b16 v[162:163], v23 offset:6400
    s_waitcnt vmcnt(14) lgkmcnt(10)
    v_mfma_f32_32x32x16_bf16 v[32:47], a[84:87], v[140:143], v[32:47]
    buffer_load_dwordx4 a[144:147], v27, s[28:31], s71 offen offset:0 sc1
    ds_read_b64_tr_b16 v[164:165], v17 offset:7168
    ds_read_b64_tr_b16 v[166:167], v17 offset:7424
    s_waitcnt lgkmcnt(10)
    v_mfma_f32_32x32x16_bf16 v[64:79], a[84:87], v[144:147], v[64:79]
    ds_read_b64_tr_b16 v[168:169], v17 offset:15360
    ds_read_b64_tr_b16 v[170:171], v17 offset:15616
    s_waitcnt lgkmcnt(10)
    v_mfma_f32_32x32x16_bf16 v[96:111], v[148:151], a[84:87], v[96:111]
    ds_read_b64_tr_b16 v[172:173], v23 offset:7168
    ds_read_b64_tr_b16 v[174:175], v23 offset:7424
    s_waitcnt vmcnt(14) lgkmcnt(10)
    v_mfma_f32_32x32x16_bf16 v[32:47], a[88:91], v[152:155], v[32:47]
    buffer_load_dwordx4 a[148:151], v27, s[28:31], s71 offen offset:1024 sc1
    ds_read_b64_tr_b16 v[128:129], v17 offset:40960
    ds_read_b64_tr_b16 v[130:131], v17 offset:41216
    s_waitcnt lgkmcnt(10)
    v_mfma_f32_32x32x16_bf16 v[64:79], a[88:91], v[156:159], v[64:79]
    ds_read_b64_tr_b16 v[132:133], v17 offset:49152
    ds_read_b64_tr_b16 v[134:135], v17 offset:49408
    s_waitcnt lgkmcnt(10)
    v_mfma_f32_32x32x16_bf16 v[96:111], v[160:163], a[88:91], v[96:111]
    ds_read_b64_tr_b16 v[136:137], v23 offset:40960
    ds_read_b64_tr_b16 v[138:139], v23 offset:41216
    s_waitcnt vmcnt(14) lgkmcnt(10)
    v_mfma_f32_32x32x16_bf16 v[32:47], a[92:95], v[164:167], v[32:47]
    buffer_load_dwordx4 a[152:155], v27, s[28:31], s71 offen offset:2048 sc1
    buffer_load_dwordx4 a[156:159], v27, s[28:31], s71 offen offset:3072 sc1
    s_add_u32 s71, s71, 4096
    ds_read_b64_tr_b16 v[140:141], v17 offset:41984
    s_waitcnt lgkmcnt(9)
    v_mfma_f32_32x32x16_bf16 v[64:79], a[92:95], v[168:171], v[64:79]
    ds_read_b64_tr_b16 v[142:143], v17 offset:42240
    ds_read_b64_tr_b16 v[144:145], v17 offset:50176
    ds_read_b64_tr_b16 v[146:147], v17 offset:50432
    s_waitcnt lgkmcnt(10)
    v_mfma_f32_32x32x16_bf16 v[96:111], v[172:175], a[92:95], v[96:111]
    ds_read_b64_tr_b16 v[148:149], v23 offset:41984
    ds_read_b64_tr_b16 v[150:151], v23 offset:42240
    s_waitcnt vmcnt(15) lgkmcnt(10)
    v_mfma_f32_32x32x16_bf16 v[32:47], a[96:99], v[128:131], v[32:47]
    buffer_load_dwordx4 a[160:163], v27, s[28:31], s71 offen offset:0 sc1
    ds_read_b64_tr_b16 v[152:153], v17 offset:43008
    ds_read_b64_tr_b16 v[154:155], v17 offset:43264
    s_waitcnt lgkmcnt(10)
    v_mfma_f32_32x32x16_bf16 v[64:79], a[96:99], v[132:135], v[64:79]
    ds_read_b64_tr_b16 v[156:157], v17 offset:51200
    ds_read_b64_tr_b16 v[158:159], v17 offset:51456
    s_waitcnt lgkmcnt(10)
    v_mfma_f32_32x32x16_bf16 v[96:111], v[136:139], a[96:99], v[96:111]
    ds_read_b64_tr_b16 v[160:161], v23 offset:43008
    ds_read_b64_tr_b16 v[162:163], v23 offset:43264
    s_waitcnt vmcnt(15) lgkmcnt(10)
    v_mfma_f32_32x32x16_bf16 v[32:47], a[100:103], v[140:143], v[32:47]
    buffer_load_dwordx4 a[164:167], v27, s[28:31], s71 offen offset:1024 sc1
    ds_read_b64_tr_b16 v[164:165], v17 offset:44032
    ds_read_b64_tr_b16 v[166:167], v17 offset:44288
    s_waitcnt lgkmcnt(10)
    v_mfma_f32_32x32x16_bf16 v[64:79], a[100:103], v[144:147], v[64:79]
    ds_read_b64_tr_b16 v[168:169], v17 offset:52224
    ds_read_b64_tr_b16 v[170:171], v17 offset:52480
    s_waitcnt lgkmcnt(10)
    v_mfma_f32_32x32x16_bf16 v[96:111], v[148:151], a[100:103], v[96:111]
    ds_read_b64_tr_b16 v[172:173], v23 offset:44032
    ds_read_b64_tr_b16 v[174:175], v23 offset:44288
    s_waitcnt vmcnt(15) lgkmcnt(10)
    v_mfma_f32_32x32x16_bf16 v[32:47], a[104:107], v[152:155], v[32:47]
    buffer_load_dwordx4 a[168:171], v27, s[28:31], s71 offen offset:2048 sc1
    buffer_load_dwordx4 a[172:175], v27, s[28:31], s71 offen offset:3072 sc1
    s_add_u32 s71, s71, 4096
    ds_read_b64_tr_b16 v[128:129], v17 offset:45056
    s_waitcnt lgkmcnt(9)
    v_mfma_f32_32x32x16_bf16 v[64:79], a[104:107], v[156:159], v[64:79]
    ds_read_b64_tr_b16 v[130:131], v17 offset:45312
    ds_read_b64_tr_b16 v[132:133], v17 offset:53248
    ds_read_b64_tr_b16 v[134:135], v17 offset:53504
    s_waitcnt lgkmcnt(10)
    v_mfma_f32_32x32x16_bf16 v[96:111], v[160:163], a[104:107], v[96:111]
    ds_read_b64_tr_b16 v[136:137], v23 offset:45056
    ds_read_b64_tr_b16 v[138:139], v23 offset:45312
    s_waitcnt vmcnt(16) lgkmcnt(10)
    v_mfma_f32_32x32x16_bf16 v[32:47], a[108:111], v[164:167], v[32:47]
    buffer_load_dwordx4 a[176:179], v27, s[28:31], s71 offen offset:0 sc1
    ds_read_b64_tr_b16 v[140:141], v17 offset:46080
    ds_read_b64_tr_b16 v[142:143], v17 offset:46336
    s_waitcnt lgkmcnt(10)
    v_mfma_f32_32x32x16_bf16 v[64:79], a[108:111], v[168:171], v[64:79]
    ds_read_b64_tr_b16 v[144:145], v17 offset:54272
    ds_read_b64_tr_b16 v[146:147], v17 offset:54528
    s_waitcnt lgkmcnt(10)
    v_mfma_f32_32x32x16_bf16 v[96:111], v[172:175], a[108:111], v[96:111]
    ds_read_b64_tr_b16 v[148:149], v23 offset:46080
    ds_read_b64_tr_b16 v[150:151], v23 offset:46336
    s_waitcnt vmcnt(16) lgkmcnt(10)
    v_mfma_f32_32x32x16_bf16 v[32:47], a[112:115], v[128:131], v[32:47]
    buffer_load_dwordx4 a[180:183], v27, s[28:31], s71 offen offset:1024 sc1
    ds_read_b64_tr_b16 v[152:153], v17 offset:47104
    ds_read_b64_tr_b16 v[154:155], v17 offset:47360
    s_waitcnt lgkmcnt(10)
    v_mfma_f32_32x32x16_bf16 v[64:79], a[112:115], v[132:135], v[64:79]
    ds_read_b64_tr_b16 v[156:157], v17 offset:55296
    ds_read_b64_tr_b16 v[158:159], v17 offset:55552
    s_waitcnt lgkmcnt(10)
    v_mfma_f32_32x32x16_bf16 v[96:111], v[136:139], a[112:115], v[96:111]
    ds_read_b64_tr_b16 v[160:161], v23 offset:47104
    ds_read_b64_tr_b16 v[162:163], v23 offset:47360
    s_waitcnt vmcnt(16) lgkmcnt(10)
    v_mfma_f32_32x32x16_bf16 v[32:47], a[116:119], v[140:143], v[32:47]
    buffer_load_dwordx4 a[184:187], v27, s[28:31], s71 offen offset:2048 sc1
    buffer_load_dwordx4 a[188:191], v27, s[28:31], s71 offen offset:3072 sc1
    s_add_u32 s71, s71, 4096
    ds_read_b64_tr_b16 v[164:165], v17 offset:48128
    s_waitcnt lgkmcnt(9)
    v_mfma_f32_32x32x16_bf16 v[64:79], a[116:119], v[144:147], v[64:79]
    ds_read_b64_tr_b16 v[166:167], v17 offset:48384
    ds_read_b64_tr_b16 v[168:169], v17 offset:56320
    ds_read_b64_tr_b16 v[170:171], v17 offset:56576
    s_waitcnt lgkmcnt(10)
    v_mfma_f32_32x32x16_bf16 v[96:111], v[148:151], a[116:119], v[96:111]
    ds_read_b64_tr_b16 v[172:173], v23 offset:48128
    ds_read_b64_tr_b16 v[174:175], v23 offset:48384
    s_waitcnt vmcnt(17) lgkmcnt(10)
    v_mfma_f32_32x32x16_bf16 v[32:47], a[120:123], v[152:155], v[32:47]
    buffer_load_dwordx4 a[192:195], v27, s[28:31], s71 offen offset:0 sc1
    ds_read_b64_tr_b16 v[128:129], v16 offset:0
    s_waitcnt lgkmcnt(9)
    v_mfma_f32_32x32x16_bf16 v[64:79], a[120:123], v[156:159], v[64:79]
    ds_read_b64_tr_b16 v[130:131], v16 offset:256
    ds_read_b64_tr_b16 v[132:133], v16 offset:8192
    s_waitcnt lgkmcnt(9)
    v_mfma_f32_32x32x16_bf16 v[96:111], v[160:163], a[120:123], v[96:111]
    ds_read_b64_tr_b16 v[134:135], v16 offset:8448
    s_waitcnt vmcnt(17) lgkmcnt(8)
    v_mfma_f32_32x32x16_bf16 v[32:47], a[124:127], v[164:167], v[32:47]
    buffer_load_dwordx4 a[196:199], v27, s[28:31], s71 offen offset:1024 sc1
    ds_read_b64_tr_b16 v[140:141], v16 offset:1024
    s_waitcnt lgkmcnt(7)
    v_mfma_f32_32x32x16_bf16 v[64:79], a[124:127], v[168:171], v[64:79]
    ds_read_b64_tr_b16 v[142:143], v16 offset:1280
    ds_read_b64_tr_b16 v[144:145], v16 offset:9216
    s_waitcnt lgkmcnt(7)
    v_mfma_f32_32x32x16_bf16 v[96:111], v[172:175], a[124:127], v[96:111]
    ds_read_b64_tr_b16 v[146:147], v16 offset:9472
    s_waitcnt vmcnt(17) lgkmcnt(6)
    v_mfma_f32_32x32x16_bf16 v[48:63], a[128:131], v[128:131], 0
    buffer_load_dwordx4 a[200:203], v27, s[28:31], s71 offen offset:2048 sc1
    ds_read_b64_tr_b16 v[152:153], v16 offset:2048
    ds_read_b64_tr_b16 v[154:155], v16 offset:2304
    s_waitcnt lgkmcnt(6)
    v_mfma_f32_32x32x16_bf16 v[80:95], a[128:131], v[132:135], 0
    ds_read_b64_tr_b16 v[156:157], v16 offset:10240
    ds_read_b64_tr_b16 v[158:159], v16 offset:10496
    s_waitcnt vmcnt(17) lgkmcnt(6)
    v_mfma_f32_32x32x16_bf16 v[48:63], a[132:135], v[140:143], v[48:63]
    buffer_load_dwordx4 a[204:207], v27, s[28:31], s71 offen offset:3072 sc1
    s_add_u32 s71, s71, 4096
    ds_read_b64_tr_b16 v[164:165], v16 offset:3072
    ds_read_b64_tr_b16 v[166:167], v16 offset:3328
    s_waitcnt lgkmcnt(6)
    v_mfma_f32_32x32x16_bf16 v[80:95], a[132:135], v[144:147], v[80:95]
    ds_read_b64_tr_b16 v[168:169], v16 offset:11264
    ds_read_b64_tr_b16 v[170:171], v16 offset:11520
    s_waitcnt vmcnt(17) lgkmcnt(6)
    v_mfma_f32_32x32x16_bf16 v[48:63], a[136:139], v[152:155], v[48:63]
    buffer_load_dwordx4 a[208:211], v27, s[28:31], s71 offen offset:0 sc1
    ds_read_b64_tr_b16 v[128:129], v16 offset:4096
    ds_read_b64_tr_b16 v[130:131], v16 offset:4352
    ds_read_b64_tr_b16 v[132:133], v16 offset:12288
    ds_read_b64_tr_b16 v[134:135], v16 offset:12544
    s_waitcnt lgkmcnt(8)
    v_mfma_f32_32x32x16_bf16 v[80:95], a[136:139], v[156:159], v[80:95]
    v_mov_b32 v240, 0x3f803f80
    v_mov_b32 v241, 0x3f803f80
    v_mov_b32 v242, 0x3f803f80
    v_mov_b32 v243, 0x3f803f80
    s_waitcnt vmcnt(17) lgkmcnt(6)
    v_mfma_f32_32x32x16_bf16 v[48:63], a[140:143], v[164:167], v[48:63]
    buffer_load_dwordx4 a[212:215], v27, s[28:31], s71 offen offset:1024 sc1
    ds_read_b64_tr_b16 v[140:141], v16 offset:5120
    ds_read_b64_tr_b16 v[142:143], v16 offset:5376
    ds_read_b64_tr_b16 v[144:145], v16 offset:13312
    ds_read_b64_tr_b16 v[146:147], v16 offset:13568
    s_waitcnt lgkmcnt(8)
    v_mfma_f32_32x32x16_bf16 v[80:95], a[140:143], v[168:171], v[80:95]
    v_cvt_pk_bf16_f32 v232, v64, v65
    v_cvt_pk_bf16_f32 v233, v66, v67
    v_cvt_pk_bf16_f32 v234, v68, v69
    v_cvt_pk_bf16_f32 v235, v70, v71
    s_waitcnt vmcnt(17) lgkmcnt(6)
    v_mfma_f32_32x32x16_bf16 v[48:63], a[144:147], v[128:131], v[48:63]
    buffer_load_dwordx4 a[216:219], v27, s[28:31], s71 offen offset:2048 sc1
    ds_read_b64_tr_b16 v[152:153], v16 offset:6144
    ds_read_b64_tr_b16 v[154:155], v16 offset:6400
    ds_read_b64_tr_b16 v[156:157], v16 offset:14336
    ds_read_b64_tr_b16 v[158:159], v16 offset:14592
    s_waitcnt lgkmcnt(8)
    v_mfma_f32_32x32x16_bf16 v[80:95], a[144:147], v[132:135], v[80:95]
    v_cvt_pk_bf16_f32 v236, v72, v73
    v_cvt_pk_bf16_f32 v237, v74, v75
    v_cvt_pk_bf16_f32 v238, v76, v77
    v_cvt_pk_bf16_f32 v239, v78, v79
    s_waitcnt vmcnt(17) lgkmcnt(6)
    v_mfma_f32_32x32x16_bf16 v[48:63], a[148:151], v[140:143], v[48:63]
    buffer_load_dwordx4 a[220:223], v27, s[28:31], s71 offen offset:3072 sc1
    s_add_u32 s71, s71, 4096
    ds_read_b64_tr_b16 v[164:165], v16 offset:7168
    ds_read_b64_tr_b16 v[166:167], v16 offset:7424
    ds_read_b64_tr_b16 v[168:169], v16 offset:15360
    ds_read_b64_tr_b16 v[170:171], v16 offset:15616
    s_waitcnt lgkmcnt(8)
    v_mfma_f32_32x32x16_bf16 v[80:95], a[148:151], v[144:147], v[80:95]
    v_mul_f32 v208, s60, v32
    v_mul_f32 v209, s60, v33
    v_mul_f32 v210, s60, v34
    v_mul_f32 v211, s60, v35
    s_waitcnt vmcnt(17) lgkmcnt(6)
    v_mfma_f32_32x32x16_bf16 v[48:63], a[152:155], v[152:155], v[48:63]
    buffer_load_dwordx4 a[224:227], v27, s[28:31], s71 offen offset:0 sc1
    ds_read_b64_tr_b16 v[128:129], v16 offset:40960
    ds_read_b64_tr_b16 v[130:131], v16 offset:41216
    ds_read_b64_tr_b16 v[132:133], v16 offset:49152
    ds_read_b64_tr_b16 v[134:135], v16 offset:49408
    s_waitcnt lgkmcnt(8)
    v_mfma_f32_32x32x16_bf16 v[80:95], a[152:155], v[156:159], v[80:95]
    v_mul_f32 v212, s60, v36
    v_mul_f32 v213, s60, v37
    v_mul_f32 v214, s60, v38
    v_mul_f32 v215, s60, v39
    s_waitcnt vmcnt(17) lgkmcnt(6)
    v_mfma_f32_32x32x16_bf16 v[48:63], a[156:159], v[164:167], v[48:63]
    buffer_load_dwordx4 a[228:231], v27, s[28:31], s71 offen offset:1024 sc1
    ds_read_b64_tr_b16 v[140:141], v16 offset:41984
    ds_read_b64_tr_b16 v[142:143], v16 offset:42240
    ds_read_b64_tr_b16 v[144:145], v16 offset:50176
    ds_read_b64_tr_b16 v[146:147], v16 offset:50432
    s_waitcnt lgkmcnt(8)
    v_mfma_f32_32x32x16_bf16 v[80:95], a[156:159], v[168:171], v[80:95]
    v_mul_f32 v216, s60, v40
    v_mul_f32 v217, s60, v41
    v_mul_f32 v218, s60, v42
    v_mul_f32 v219, s60, v43
    s_waitcnt vmcnt(17) lgkmcnt(6)
    v_mfma_f32_32x32x16_bf16 v[48:63], a[160:163], v[128:131], v[48:63]
    buffer_load_dwordx4 a[232:235], v27, s[28:31], s71 offen offset:2048 sc1
    ds_read_b64_tr_b16 v[152:153], v16 offset:43008
    ds_read_b64_tr_b16 v[154:155], v16 offset:43264
    ds_read_b64_tr_b16 v[156:157], v16 offset:51200
    ds_read_b64_tr_b16 v[158:159], v16 offset:51456
    s_waitcnt lgkmcnt(8)
    v_mfma_f32_32x32x16_bf16 v[80:95], a[160:163], v[132:135], v[80:95]
    v_mul_f32 v220, s60, v44
    v_mul_f32 v221, s60, v45
    v_mul_f32 v222, s60, v46
    v_mul_f32 v223, s60, v47
    s_waitcnt vmcnt(17) lgkmcnt(6)
    v_mfma_f32_32x32x16_bf16 v[48:63], a[164:167], v[140:143], v[48:63]
    buffer_load_dwordx4 a[236:239], v27, s[28:31], s71 offen offset:3072 sc1
    s_add_u32 s71, s71, 4096
    ds_read_b64_tr_b16 v[164:165], v16 offset:44032
    ds_read_b64_tr_b16 v[166:167], v16 offset:44288
    ds_read_b64_tr_b16 v[168:169], v16 offset:52224
    ds_read_b64_tr_b16 v[170:171], v16 offset:52480
    s_waitcnt lgkmcnt(8)
    v_mfma_f32_32x32x16_bf16 v[80:95], a[164:167], v[144:147], v[80:95]
    v_exp_f32_e64 v208, v208 clamp
    v_max_f32 v32, 0, v32
    v_exp_f32_e64 v209, v209 clamp
    v_max_f32 v33, 0, v33
    s_waitcnt vmcnt(17) lgkmcnt(6)
    v_mfma_f32_32x32x16_bf16 v[48:63], a[168:171], v[152:155], v[48:63]
    buffer_load_dwordx4 a[240:243], v27, s[28:31], s71 offen offset:0 sc1
    ds_read_b64_tr_b16 v[128:129], v16 offset:45056
    ds_read_b64_tr_b16 v[130:131], v16 offset:45312
    ds_read_b64_tr_b16 v[132:133], v16 offset:53248
    ds_read_b64_tr_b16 v[134:135], v16 offset:53504
    s_waitcnt lgkmcnt(8)
    v_mfma_f32_32x32x16_bf16 v[80:95], a[168:171], v[156:159], v[80:95]
    v_exp_f32_e64 v210, v210 clamp
    v_max_f32 v34, 0, v34
    v_exp_f32_e64 v211, v211 clamp
    v_max_f32 v35, 0, v35
    s_waitcnt vmcnt(17) lgkmcnt(6)
    v_mfma_f32_32x32x16_bf16 v[48:63], a[172:175], v[164:167], v[48:63]
    buffer_load_dwordx4 a[244:247], v27, s[28:31], s71 offen offset:1024 sc1
    ds_read_b64_tr_b16 v[140:141], v16 offset:46080
    ds_read_b64_tr_b16 v[142:143], v16 offset:46336
    ds_read_b64_tr_b16 v[144:145], v16 offset:54272
    ds_read_b64_tr_b16 v[146:147], v16 offset:54528
    s_waitcnt lgkmcnt(8)
    v_mfma_f32_32x32x16_bf16 v[80:95], a[172:175], v[168:171], v[80:95]
    v_exp_f32_e64 v212, v212 clamp
    v_max_f32 v36, 0, v36
    v_exp_f32_e64 v213, v213 clamp
    v_max_f32 v37, 0, v37
    s_waitcnt vmcnt(17) lgkmcnt(6)
    v_mfma_f32_32x32x16_bf16 v[48:63], a[176:179], v[128:131], v[48:63]
    buffer_load_dwordx4 a[248:251], v27, s[28:31], s71 offen offset:2048 sc1
    ds_read_b64_tr_b16 v[152:153], v16 offset:47104
    ds_read_b64_tr_b16 v[154:155], v16 offset:47360
    ds_read_b64_tr_b16 v[156:157], v16 offset:55296
    ds_read_b64_tr_b16 v[158:159], v16 offset:55552
    s_waitcnt lgkmcnt(8)
    v_mfma_f32_32x32x16_bf16 v[80:95], a[176:179], v[132:135], v[80:95]
    v_exp_f32_e64 v214, v214 clamp
    v_max_f32 v38, 0, v38
    v_exp_f32_e64 v215, v215 clamp
    v_max_f32 v39, 0, v39
    s_waitcnt vmcnt(17) lgkmcnt(6)
    v_mfma_f32_32x32x16_bf16 v[48:63], a[180:183], v[140:143], v[48:63]
    buffer_load_dwordx4 a[252:255], v27, s[28:31], s71 offen offset:3072 sc1
    ds_read_b64_tr_b16 v[164:165], v16 offset:48128
    ds_read_b64_tr_b16 v[166:167], v16 offset:48384
    ds_read_b64_tr_b16 v[168:169], v16 offset:56320
    ds_read_b64_tr_b16 v[170:171], v16 offset:56576
    s_waitcnt lgkmcnt(8)
    v_mfma_f32_32x32x16_bf16 v[80:95], a[180:183], v[144:147], v[80:95]
    v_exp_f32_e64 v216, v216 clamp
    v_max_f32 v40, 0, v40
    v_exp_f32_e64 v217, v217 clamp
    v_max_f32 v41, 0, v41
    s_waitcnt vmcnt(17) lgkmcnt(6)
    v_mfma_f32_32x32x16_bf16 v[48:63], a[184:187], v[152:155], v[48:63]
    ds_read_b64_tr_b16 v[128:129], v17 offset:0
    ds_read_b64_tr_b16 v[130:131], v17 offset:256
    ds_read_b64_tr_b16 v[132:133], v17 offset:8192
    ds_read_b64_tr_b16 v[134:135], v17 offset:8448
    s_waitcnt lgkmcnt(8)
    v_mfma_f32_32x32x16_bf16 v[80:95], a[184:187], v[156:159], v[80:95]
    v_exp_f32_e64 v218, v218 clamp
    v_max_f32 v42, 0, v42
    v_exp_f32_e64 v219, v219 clamp
    v_max_f32 v43, 0, v43
    s_waitcnt vmcnt(16) lgkmcnt(6)
    v_mfma_f32_32x32x16_bf16 v[48:63], a[188:191], v[164:167], v[48:63]
    s_lshl2_add_u32 s59, s76, s3
    s_lshl_b32 s59, s59, 10
    buffer_load_dword v25, v27, s[44:47], s59 offen
    ds_read_b64_tr_b16 v[140:141], v17 offset:1024
    ds_read_b64_tr_b16 v[142:143], v17 offset:1280
    ds_read_b64_tr_b16 v[144:145], v17 offset:9216
    ds_read_b64_tr_b16 v[146:147], v17 offset:9472
    s_waitcnt lgkmcnt(8)
    v_mfma_f32_32x32x16_bf16 v[80:95], a[188:191], v[168:171], v[80:95]
    v_exp_f32_e64 v220, v220 clamp
    v_max_f32 v44, 0, v44
    v_exp_f32_e64 v221, v221 clamp
    v_max_f32 v45, 0, v45
    s_waitcnt vmcnt(16) lgkmcnt(6)
    v_mfma_f32_32x32x16_bf16 v[48:63], a[192:195], v[128:131], v[48:63]
    ds_read_b64_tr_b16 v[152:153], v17 offset:2048
    ds_read_b64_tr_b16 v[154:155], v17 offset:2304
    ds_read_b64_tr_b16 v[156:157], v17 offset:10240
    ds_read_b64_tr_b16 v[158:159], v17 offset:10496
    s_waitcnt lgkmcnt(8)
    v_mfma_f32_32x32x16_bf16 v[80:95], a[192:195], v[132:135], v[80:95]
    v_exp_f32_e64 v222, v222 clamp
    v_max_f32 v46, 0, v46
    v_exp_f32_e64 v223, v223 clamp
    v_max_f32 v47, 0, v47
    s_waitcnt vmcnt(15) lgkmcnt(6)
    v_mfma_f32_32x32x16_bf16 v[48:63], a[196:199], v[140:143], v[48:63]
    s_add_u32 m0, s67, 16384
    s_cmp_ge_u32 s10, 11
    s_cselect_b32 s11, -11, 0
    s_lshl_b32 s11, s11, 17
    s_add_u32 s11, s11, s65
    buffer_load_dwordx4 v2, s[40:43], s11 offen offset:0 lds
    ds_read_b64_tr_b16 v[164:165], v17 offset:3072
    ds_read_b64_tr_b16 v[166:167], v17 offset:3328
    ds_read_b64_tr_b16 v[168:169], v17 offset:11264
    ds_read_b64_tr_b16 v[170:171], v17 offset:11520
    s_waitcnt lgkmcnt(8)
    v_mfma_f32_32x32x16_bf16 v[80:95], a[196:199], v[144:147], v[80:95]
    v_add_f32 v32, v208, v32
    v_add_f32 v33, v209, v33
    v_add_f32 v34, v210, v34
    v_add_f32 v35, v211, v35
    s_waitcnt vmcnt(15) lgkmcnt(6)
    v_mfma_f32_32x32x16_bf16 v[48:63], a[200:203], v[152:155], v[48:63]
    ds_read_b64_tr_b16 v[128:129], v17 offset:4096
    ds_read_b64_tr_b16 v[130:131], v17 offset:4352
    ds_read_b64_tr_b16 v[132:133], v17 offset:12288
    ds_read_b64_tr_b16 v[134:135], v17 offset:12544
    s_waitcnt lgkmcnt(8)
    v_mfma_f32_32x32x16_bf16 v[80:95], a[200:203], v[156:159], v[80:95]
    v_add_f32 v36, v212, v36
    v_add_f32 v37, v213, v37
    v_add_f32 v38, v214, v38
    v_add_f32 v39, v215, v39
    s_waitcnt vmcnt(14) lgkmcnt(6)
    v_mfma_f32_32x32x16_bf16 v[48:63], a[204:207], v[164:167], v[48:63]
    buffer_load_dwordx4 v3, s[40:43], s11 offen offset:1024 lds
    ds_read_b64_tr_b16 v[140:141], v17 offset:5120
    ds_read_b64_tr_b16 v[142:143], v17 offset:5376
    ds_read_b64_tr_b16 v[144:145], v17 offset:13312
    ds_read_b64_tr_b16 v[146:147], v17 offset:13568
    s_waitcnt lgkmcnt(8)
    v_mfma_f32_32x32x16_bf16 v[80:95], a[204:207], v[168:171], v[80:95]
    v_add_f32 v40, v216, v40
    v_add_f32 v41, v217, v41
    v_add_f32 v42, v218, v42
    v_add_f32 v43, v219, v43
    s_waitcnt vmcnt(14) lgkmcnt(6)
    v_mfma_f32_32x32x16_bf16 v[48:63], a[208:211], v[128:131], v[48:63]
    ds_read_b64_tr_b16 v[152:153], v17 offset:6144
    ds_read_b64_tr_b16 v[154:155], v17 offset:6400
    ds_read_b64_tr_b16 v[156:157], v17 offset:14336
    ds_read_b64_tr_b16 v[158:159], v17 offset:14592
    s_waitcnt lgkmcnt(8)
    v_mfma_f32_32x32x16_bf16 v[80:95], a[208:211], v[132:135], v[80:95]
    v_add_f32 v44, v220, v44
    v_add_f32 v45, v221, v45
    v_add_f32 v46, v222, v46
    v_add_f32 v47, v223, v47
    s_waitcnt vmcnt(13) lgkmcnt(6)
    v_mfma_f32_32x32x16_bf16 v[48:63], a[212:215], v[140:143], v[48:63]
    buffer_load_dwordx4 v4, s[40:43], s11 offen offset:2048 lds
    ds_read_b64_tr_b16 v[164:165], v17 offset:7168
    ds_read_b64_tr_b16 v[166:167], v17 offset:7424
    ds_read_b64_tr_b16 v[168:169], v17 offset:15360
    ds_read_b64_tr_b16 v[170:171], v17 offset:15616
    s_waitcnt lgkmcnt(8)
    v_mfma_f32_32x32x16_bf16 v[80:95], a[212:215], v[144:147], v[80:95]
    v_add_f32 v32, v24, v32
    v_add_f32 v33, v24, v33
    v_add_f32 v34, v24, v34
    v_add_f32 v35, v24, v35
    s_waitcnt vmcnt(13) lgkmcnt(6)
    v_mfma_f32_32x32x16_bf16 v[48:63], a[216:219], v[152:155], v[48:63]
    ds_read_b64_tr_b16 v[128:129], v17 offset:40960
    ds_read_b64_tr_b16 v[130:131], v17 offset:41216
    ds_read_b64_tr_b16 v[132:133], v17 offset:49152
    ds_read_b64_tr_b16 v[134:135], v17 offset:49408
    s_waitcnt lgkmcnt(8)
    v_mfma_f32_32x32x16_bf16 v[80:95], a[216:219], v[156:159], v[80:95]
    v_add_f32 v36, v24, v36
    v_add_f32 v37, v24, v37
    v_add_f32 v38, v24, v38
    v_add_f32 v39, v24, v39
    s_waitcnt vmcnt(12) lgkmcnt(6)
    v_mfma_f32_32x32x16_bf16 v[48:63], a[220:223], v[164:167], v[48:63]
    buffer_load_dwordx4 v5, s[40:43], s11 offen offset:3072 lds
    ds_read_b64_tr_b16 v[140:141], v17 offset:41984
    ds_read_b64_tr_b16 v[142:143], v17 offset:42240
    ds_read_b64_tr_b16 v[144:145], v17 offset:50176
    ds_read_b64_tr_b16 v[146:147], v17 offset:50432
    s_waitcnt lgkmcnt(8)
    v_mfma_f32_32x32x16_bf16 v[80:95], a[220:223], v[168:171], v[80:95]
    v_add_f32 v40, v24, v40
    v_add_f32 v41, v24, v41
    v_add_f32 v42, v24, v42
    v_add_f32 v43, v24, v43
    s_waitcnt vmcnt(12) lgkmcnt(6)
    v_mfma_f32_32x32x16_bf16 v[48:63], a[224:227], v[128:131], v[48:63]
    ds_read_b64_tr_b16 v[152:153], v17 offset:43008
    ds_read_b64_tr_b16 v[154:155], v17 offset:43264
    ds_read_b64_tr_b16 v[156:157], v17 offset:51200
    ds_read_b64_tr_b16 v[158:159], v17 offset:51456
    s_waitcnt lgkmcnt(8)
    v_mfma_f32_32x32x16_bf16 v[80:95], a[224:227], v[132:135], v[80:95]
    v_add_f32 v44, v24, v44
    v_add_f32 v45, v24, v45
    v_add_f32 v46, v24, v46
    v_add_f32 v47, v24, v47
    s_waitcnt vmcnt(11) lgkmcnt(6)
    v_mfma_f32_32x32x16_bf16 v[48:63], a[228:231], v[140:143], v[48:63]
    s_add_u32 m0, s67, 20480
    s_cmp_ge_u32 s10, 10
    s_cselect_b32 s11, -10, 1
    s_lshl_b32 s11, s11, 17
    s_add_u32 s11, s11, s65
    buffer_load_dwordx4 v2, s[40:43], s11 offen offset:0 lds
    ds_read_b64_tr_b16 v[164:165], v17 offset:44032
    ds_read_b64_tr_b16 v[166:167], v17 offset:44288
    ds_read_b64_tr_b16 v[168:169], v17 offset:52224
    ds_read_b64_tr_b16 v[170:171], v17 offset:52480
    s_waitcnt lgkmcnt(8)
    v_mfma_f32_32x32x16_bf16 v[80:95], a[228:231], v[144:147], v[80:95]
    v_cvt_pk_bf16_f32 v224, v32, v33
    v_cvt_pk_bf16_f32 v225, v34, v35
    v_cvt_pk_bf16_f32 v226, v36, v37
    v_cvt_pk_bf16_f32 v227, v38, v39
    s_waitcnt vmcnt(11) lgkmcnt(6)
    v_mfma_f32_32x32x16_bf16 v[48:63], a[232:235], v[152:155], v[48:63]
    ds_read_b64_tr_b16 v[128:129], v17 offset:45056
    ds_read_b64_tr_b16 v[130:131], v17 offset:45312
    ds_read_b64_tr_b16 v[132:133], v17 offset:53248
    ds_read_b64_tr_b16 v[134:135], v17 offset:53504
    s_waitcnt lgkmcnt(8)
    v_mfma_f32_32x32x16_bf16 v[80:95], a[232:235], v[156:159], v[80:95]
    v_cvt_pk_bf16_f32 v228, v40, v41
    v_cvt_pk_bf16_f32 v229, v42, v43
    v_cvt_pk_bf16_f32 v230, v44, v45
    v_cvt_pk_bf16_f32 v231, v46, v47
    s_waitcnt vmcnt(10) lgkmcnt(6)
    v_mfma_f32_32x32x16_bf16 v[48:63], a[236:239], v[164:167], v[48:63]
    buffer_load_dwordx4 v3, s[40:43], s11 offen offset:1024 lds
    ds_read_b64_tr_b16 v[140:141], v17 offset:46080
    ds_read_b64_tr_b16 v[142:143], v17 offset:46336
    ds_read_b64_tr_b16 v[144:145], v17 offset:54272
    ds_read_b64_tr_b16 v[146:147], v17 offset:54528
    s_waitcnt lgkmcnt(8)
    v_mfma_f32_32x32x16_bf16 v[80:95], a[236:239], v[168:171], v[80:95]
    v_mfma_f32_32x32x16_bf16 v[176:191], v[224:227], v[232:235], 0
    v_mfma_f32_32x32x16_bf16 v[192:207], v[224:227], v[240:243], 0
    v_mfma_f32_32x32x16_bf16 v[176:191], v[228:231], v[236:239], v[176:191]
    v_mfma_f32_32x32x16_bf16 v[192:207], v[228:231], v[240:243], v[192:207]
    s_waitcnt vmcnt(10) lgkmcnt(6)
    v_mfma_f32_32x32x16_bf16 v[48:63], a[240:243], v[128:131], v[48:63]
    ds_read_b64_tr_b16 v[152:153], v17 offset:47104
    ds_read_b64_tr_b16 v[154:155], v17 offset:47360
    s_waitcnt lgkmcnt(6)
    v_mfma_f32_32x32x16_bf16 v[80:95], a[240:243], v[132:135], v[80:95]
    ds_read_b64_tr_b16 v[156:157], v17 offset:55296
    ds_read_b64_tr_b16 v[158:159], v17 offset:55552
    s_waitcnt vmcnt(9) lgkmcnt(6)
    v_mfma_f32_32x32x16_bf16 v[48:63], a[244:247], v[140:143], v[48:63]
    buffer_load_dwordx4 v4, s[40:43], s11 offen offset:2048 lds
    ds_read_b64_tr_b16 v[164:165], v17 offset:48128
    ds_read_b64_tr_b16 v[166:167], v17 offset:48384
    s_waitcnt lgkmcnt(6)
    v_mfma_f32_32x32x16_bf16 v[80:95], a[244:247], v[144:147], v[80:95]
    ds_read_b64_tr_b16 v[168:169], v17 offset:56320
    ds_read_b64_tr_b16 v[170:171], v17 offset:56576
    s_waitcnt vmcnt(9) lgkmcnt(6)
    v_mfma_f32_32x32x16_bf16 v[48:63], a[248:251], v[152:155], v[48:63]
    s_waitcnt lgkmcnt(4)
    v_mfma_f32_32x32x16_bf16 v[80:95], a[248:251], v[156:159], v[80:95]
    s_waitcnt vmcnt(8) lgkmcnt(2)
    v_mfma_f32_32x32x16_bf16 v[48:63], a[252:255], v[164:167], v[48:63]
    buffer_load_dwordx4 v5, s[40:43], s11 offen offset:3072 lds
    s_waitcnt lgkmcnt(0)
    v_mfma_f32_32x32x16_bf16 v[80:95], a[252:255], v[168:171], v[80:95]
    s_nop 11
    v_cvt_pk_bf16_f32 v232, v80, v81
    v_cvt_pk_bf16_f32 v233, v82, v83
    v_cvt_pk_bf16_f32 v234, v84, v85
    v_cvt_pk_bf16_f32 v235, v86, v87
    v_cvt_pk_bf16_f32 v236, v88, v89
    v_cvt_pk_bf16_f32 v237, v90, v91
    v_cvt_pk_bf16_f32 v238, v92, v93
    v_cvt_pk_bf16_f32 v239, v94, v95
    v_pk_mul_f32 v[208:209], v[48:49], s[60:61] op_sel_hi:[1,0]
    v_pk_mul_f32 v[210:211], v[50:51], s[60:61] op_sel_hi:[1,0]
    v_pk_mul_f32 v[212:213], v[52:53], s[60:61] op_sel_hi:[1,0]
    v_pk_mul_f32 v[214:215], v[54:55], s[60:61] op_sel_hi:[1,0]
    v_pk_mul_f32 v[216:217], v[56:57], s[60:61] op_sel_hi:[1,0]
    v_pk_mul_f32 v[218:219], v[58:59], s[60:61] op_sel_hi:[1,0]
    v_pk_mul_f32 v[220:221], v[60:61], s[60:61] op_sel_hi:[1,0]
    v_pk_mul_f32 v[222:223], v[62:63], s[60:61] op_sel_hi:[1,0]
    v_exp_f32_e64 v208, v208 clamp
    v_max_f32 v48, 0, v48
    v_exp_f32_e64 v209, v209 clamp
    v_max_f32 v49, 0, v49
    v_exp_f32_e64 v210, v210 clamp
    v_max_f32 v50, 0, v50
    v_exp_f32_e64 v211, v211 clamp
    v_max_f32 v51, 0, v51
    v_exp_f32_e64 v212, v212 clamp
    v_max_f32 v52, 0, v52
    v_exp_f32_e64 v213, v213 clamp
    v_max_f32 v53, 0, v53
    v_exp_f32_e64 v214, v214 clamp
    v_max_f32 v54, 0, v54
    v_exp_f32_e64 v215, v215 clamp
    v_max_f32 v55, 0, v55
    v_exp_f32_e64 v216, v216 clamp
    v_max_f32 v56, 0, v56
    v_exp_f32_e64 v217, v217 clamp
    v_max_f32 v57, 0, v57
    v_exp_f32_e64 v218, v218 clamp
    v_max_f32 v58, 0, v58
    v_exp_f32_e64 v219, v219 clamp
    v_max_f32 v59, 0, v59
    v_exp_f32_e64 v220, v220 clamp
    v_max_f32 v60, 0, v60
    v_exp_f32_e64 v221, v221 clamp
    v_max_f32 v61, 0, v61
    v_exp_f32_e64 v222, v222 clamp
    v_max_f32 v62, 0, v62
    v_exp_f32_e64 v223, v223 clamp
    v_max_f32 v63, 0, v63
    v_pk_add_f32 v[48:49], v[48:49], v[208:209]
    v_pk_add_f32 v[50:51], v[50:51], v[210:211]
    v_pk_add_f32 v[52:53], v[52:53], v[212:213]
    v_pk_add_f32 v[54:55], v[54:55], v[214:215]
    v_pk_add_f32 v[56:57], v[56:57], v[216:217]
    v_pk_add_f32 v[58:59], v[58:59], v[218:219]
    v_pk_add_f32 v[60:61], v[60:61], v[220:221]
    v_pk_add_f32 v[62:63], v[62:63], v[222:223]
    s_waitcnt vmcnt(8)
    v_pk_add_f32 v[48:49], v[48:49], v[24:25] op_sel_hi:[1,0]
    v_pk_add_f32 v[50:51], v[50:51], v[24:25] op_sel_hi:[1,0]
    v_pk_add_f32 v[52:53], v[52:53], v[24:25] op_sel_hi:[1,0]
    v_pk_add_f32 v[54:55], v[54:55], v[24:25] op_sel_hi:[1,0]
    v_pk_add_f32 v[56:57], v[56:57], v[24:25] op_sel_hi:[1,0]
    v_pk_add_f32 v[58:59], v[58:59], v[24:25] op_sel_hi:[1,0]
    v_pk_add_f32 v[60:61], v[60:61], v[24:25] op_sel_hi:[1,0]
    v_pk_add_f32 v[62:63], v[62:63], v[24:25] op_sel_hi:[1,0]
    v_cvt_pk_bf16_f32 v224, v48, v49
    v_cvt_pk_bf16_f32 v225, v50, v51
    v_cvt_pk_bf16_f32 v226, v52, v53
    v_cvt_pk_bf16_f32 v227, v54, v55
    v_cvt_pk_bf16_f32 v228, v56, v57
    v_cvt_pk_bf16_f32 v229, v58, v59
    v_cvt_pk_bf16_f32 v230, v60, v61
    v_cvt_pk_bf16_f32 v231, v62, v63
    v_mfma_f32_32x32x16_bf16 v[176:191], v[224:227], v[232:235], v[176:191]
    v_mfma_f32_32x32x16_bf16 v[192:207], v[224:227], v[240:243], v[192:207]
    v_mfma_f32_32x32x16_bf16 v[176:191], v[228:231], v[236:239], v[176:191]
    v_mfma_f32_32x32x16_bf16 v[192:207], v[228:231], v[240:243], v[192:207]
    s_lshl4_add_u32 s72, s57, s58
    s_lshl2_add_u32 s72, s72, s3
    s_lshl_b32 s72, s72, 10
    s_add_u32 s72, s72, 0x80000
    s_lshl3_add_u32 s73, s58, s57
    s_lshl2_add_u32 s73, s73, s3
    s_lshl_b32 s73, s73, 7
    s_add_u32 s73, s73, 0x40000
    s_nop 3
    v_cndmask_b32 v208, v192, v176, s[78:79]
    v_cndmask_b32 v209, v193, v177, s[78:79]
    v_cndmask_b32 v210, v194, v178, s[78:79]
    v_cndmask_b32 v211, v195, v179, s[78:79]
    ds_write_b128 v18, v[208:211] offset:0
    v_cndmask_b32 v212, v196, v180, s[78:79]
    v_cndmask_b32 v213, v197, v181, s[78:79]
    v_cndmask_b32 v214, v198, v182, s[78:79]
    v_cndmask_b32 v215, v199, v183, s[78:79]
    ds_write_b128 v18, v[212:215] offset:1024
    v_cndmask_b32 v216, v184, v200, s[78:79]
    v_cndmask_b32 v217, v185, v201, s[78:79]
    v_cndmask_b32 v218, v186, v202, s[78:79]
    v_cndmask_b32 v219, v187, v203, s[78:79]
    ds_write_b128 v18, v[216:219] offset:2048
    v_cndmask_b32 v220, v188, v204, s[78:79]
    v_cndmask_b32 v221, v189, v205, s[78:79]
    v_cndmask_b32 v222, v190, v206, s[78:79]
    v_cndmask_b32 v223, v191, v207, s[78:79]
    ds_write_b128 v18, v[220:223] offset:3072
    s_waitcnt lgkmcnt(0)
    s_barrier
    ds_read_b128 v[208:211], v19 offset:0
    ds_read_b128 v[212:215], v19 offset:40960
    ds_read_b128 v[216:219], v20 offset:0
    ds_read_b128 v[220:223], v20 offset:40960
    s_waitcnt lgkmcnt(2)
    v_pk_add_f32 v[208:209], v[208:209], v[212:213]
    v_pk_add_f32 v[210:211], v[210:211], v[214:215]
    s_waitcnt lgkmcnt(0)
    v_pk_add_f32 v[216:217], v[216:217], v[220:221]
    v_pk_add_f32 v[218:219], v[218:219], v[222:223]
    v_pk_add_f32 v[208:209], v[208:209], v[216:217]
    v_pk_add_f32 v[210:211], v[210:211], v[218:219]
    buffer_store_dwordx4 v[208:211], v27, s[28:31], s72 offen sc1
    ds_read_b64_tr_b16 v[136:137], v22 offset:0
    ds_read_b64_tr_b16 v[138:139], v22 offset:256
    ds_read_b64_tr_b16 v[148:149], v22 offset:1024
    ds_read_b64_tr_b16 v[150:151], v22 offset:1280
    ds_read_b64_tr_b16 v[160:161], v22 offset:2048
    ds_read_b64_tr_b16 v[162:163], v22 offset:2304
    s_waitcnt lgkmcnt(4)
    v_mfma_f32_32x32x16_bf16 v[112:127], v[136:139], a[128:131], 0
    ds_read_b64_tr_b16 v[172:173], v22 offset:3072
    ds_read_b64_tr_b16 v[174:175], v22 offset:3328
    v_mul_f32 v240, s60, v96
    v_mul_f32 v241, s60, v97
    v_mul_f32 v242, s60, v98
    s_waitcnt lgkmcnt(4)
    v_mfma_f32_32x32x16_bf16 v[112:127], v[148:151], a[132:135], v[112:127]
    ds_read_b64_tr_b16 v[136:137], v22 offset:4096
    ds_read_b64_tr_b16 v[138:139], v22 offset:4352
    v_mul_f32 v243, s60, v99
    v_mul_f32 v244, s60, v100
    v_mul_f32 v245, s60, v101
    s_waitcnt lgkmcnt(4)
    v_mfma_f32_32x32x16_bf16 v[112:127], v[160:163], a[136:139], v[112:127]
    ds_read_b64_tr_b16 v[148:149], v22 offset:5120
    ds_read_b64_tr_b16 v[150:151], v22 offset:5376
    v_mul_f32 v246, s60, v102
    v_mul_f32 v247, s60, v103
    v_mul_f32 v248, s60, v104
    s_waitcnt lgkmcnt(4)
    v_mfma_f32_32x32x16_bf16 v[112:127], v[172:175], a[140:143], v[112:127]
    ds_read_b64_tr_b16 v[160:161], v22 offset:6144
    ds_read_b64_tr_b16 v[162:163], v22 offset:6400
    v_mul_f32 v249, s60, v105
    v_mul_f32 v250, s60, v106
    v_mul_f32 v251, s60, v107
    s_waitcnt lgkmcnt(4)
    v_mfma_f32_32x32x16_bf16 v[112:127], v[136:139], a[144:147], v[112:127]
    ds_read_b64_tr_b16 v[172:173], v22 offset:7168
    ds_read_b64_tr_b16 v[174:175], v22 offset:7424
    v_mul_f32 v252, s60, v108
    v_mul_f32 v253, s60, v109
    v_mul_f32 v254, s60, v110
    s_waitcnt lgkmcnt(4)
    v_mfma_f32_32x32x16_bf16 v[112:127], v[148:151], a[148:151], v[112:127]
    ds_read_b64_tr_b16 v[136:137], v22 offset:40960
    ds_read_b64_tr_b16 v[138:139], v22 offset:41216
    v_mul_f32 v255, s60, v111
    v_exp_f32_e64 v240, v240 clamp
    v_max_f32 v96, 0, v96
    s_waitcnt lgkmcnt(4)
    v_mfma_f32_32x32x16_bf16 v[112:127], v[160:163], a[152:155], v[112:127]
    ds_read_b64_tr_b16 v[148:149], v22 offset:41984
    ds_read_b64_tr_b16 v[150:151], v22 offset:42240
    v_exp_f32_e64 v241, v241 clamp
    v_max_f32 v97, 0, v97
    v_exp_f32_e64 v242, v242 clamp
    s_waitcnt lgkmcnt(4)
    v_mfma_f32_32x32x16_bf16 v[112:127], v[172:175], a[156:159], v[112:127]
    ds_read_b64_tr_b16 v[160:161], v22 offset:43008
    ds_read_b64_tr_b16 v[162:163], v22 offset:43264
    v_max_f32 v98, 0, v98
    v_exp_f32_e64 v243, v243 clamp
    v_max_f32 v99, 0, v99
    s_waitcnt lgkmcnt(4)
    v_mfma_f32_32x32x16_bf16 v[112:127], v[136:139], a[160:163], v[112:127]
    ds_read_b64_tr_b16 v[172:173], v22 offset:44032
    ds_read_b64_tr_b16 v[174:175], v22 offset:44288
    v_exp_f32_e64 v244, v244 clamp
    v_max_f32 v100, 0, v100
    v_exp_f32_e64 v245, v245 clamp
    s_waitcnt lgkmcnt(4)
    v_mfma_f32_32x32x16_bf16 v[112:127], v[148:151], a[164:167], v[112:127]
    ds_read_b64_tr_b16 v[136:137], v22 offset:45056
    ds_read_b64_tr_b16 v[138:139], v22 offset:45312
    v_max_f32 v101, 0, v101
    v_exp_f32_e64 v246, v246 clamp
    v_max_f32 v102, 0, v102
    s_waitcnt lgkmcnt(4)
    v_mfma_f32_32x32x16_bf16 v[112:127], v[160:163], a[168:171], v[112:127]
    ds_read_b64_tr_b16 v[148:149], v22 offset:46080
    ds_read_b64_tr_b16 v[150:151], v22 offset:46336
    v_exp_f32_e64 v247, v247 clamp
    v_max_f32 v103, 0, v103
    v_exp_f32_e64 v248, v248 clamp
    s_waitcnt lgkmcnt(4)
    v_mfma_f32_32x32x16_bf16 v[112:127], v[172:175], a[172:175], v[112:127]
    ds_read_b64_tr_b16 v[160:161], v22 offset:47104
    ds_read_b64_tr_b16 v[162:163], v22 offset:47360
    v_max_f32 v104, 0, v104
    v_exp_f32_e64 v249, v249 clamp
    v_max_f32 v105, 0, v105
    s_waitcnt lgkmcnt(4)
    v_mfma_f32_32x32x16_bf16 v[112:127], v[136:139], a[176:179], v[112:127]
    ds_read_b64_tr_b16 v[172:173], v22 offset:48128
    ds_read_b64_tr_b16 v[174:175], v22 offset:48384
    v_exp_f32_e64 v250, v250 clamp
    v_max_f32 v106, 0, v106
    v_exp_f32_e64 v251, v251 clamp
    s_waitcnt lgkmcnt(4)
    v_mfma_f32_32x32x16_bf16 v[112:127], v[148:151], a[180:183], v[112:127]
    ds_read_b64_tr_b16 v[136:137], v23 offset:0
    ds_read_b64_tr_b16 v[138:139], v23 offset:256
    v_max_f32 v107, 0, v107
    v_exp_f32_e64 v252, v252 clamp
    v_max_f32 v108, 0, v108
    s_waitcnt lgkmcnt(4)
    v_mfma_f32_32x32x16_bf16 v[112:127], v[160:163], a[184:187], v[112:127]
    ds_read_b64_tr_b16 v[148:149], v23 offset:1024
    ds_read_b64_tr_b16 v[150:151], v23 offset:1280
    v_exp_f32_e64 v253, v253 clamp
    v_max_f32 v109, 0, v109
    v_exp_f32_e64 v254, v254 clamp
    s_waitcnt vmcnt(0)
    s_mov_b64 exec, 1
    buffer_store_dwordx2 v[28:29], off, s[28:31], s73 sc1
    s_mov_b64 exec, -1
    s_lshr_b32 s59, s3, 1
    s_lshl1_add_u32 s62, s58, s59
    s_lshl_b32 s62, s62, 11
    s_and_b32 s63, s3, 1
    s_lshl_b32 s64, s63, 8
    s_add_u32 s62, s62, s64
    s_add_u32 s62, s62, 0x40000
    v_lshrrev_b32 v21, 4, v1
    v_bfe_u32 v25, v1, 3, 1
    v_lshlrev_b32 v25, 7, v25
    v_lshl_add_u32 v21, v21, 9, v25
    v_add_u32 v19, 32768, v27
    v_add_u32 v20, 81920, v19
    v_add_u32 v26, s62, v21
    s_lshl_b32 s59, s59, 6
    s_add_u32 s59, s59, s58
    s_lshl1_add_u32 s59, s59, s63
    s_lshl_b32 s72, s59, 11
    s_add_u32 s72, s72, 0x80000
    s_waitcnt lgkmcnt(4)
    v_mfma_f32_32x32x16_bf16 v[112:127], v[172:175], a[188:191], v[112:127]
    ds_read_b64_tr_b16 v[160:161], v23 offset:2048
    ds_read_b64_tr_b16 v[162:163], v23 offset:2304
    v_max_f32 v110, 0, v110
    v_exp_f32_e64 v255, v255 clamp
    v_max_f32 v111, 0, v111
    s_add_u32 m0, s67, 36864
    s_cmp_ge_u32 s10, 9
    s_cselect_b32 s11, -9, 2
    s_lshl_b32 s11, s11, 17
    s_add_u32 s11, s11, s65
    buffer_load_dwordx4 v2, s[40:43], s11 offen offset:0 lds
    s_waitcnt lgkmcnt(4)
    v_mfma_f32_32x32x16_bf16 v[112:127], v[136:139], a[192:195], v[112:127]
    ds_read_b64_tr_b16 v[172:173], v23 offset:3072
    ds_read_b64_tr_b16 v[174:175], v23 offset:3328
    v_add_f32 v96, v240, v96
    v_add_f32 v97, v241, v97
    v_add_f32 v98, v242, v98
    buffer_load_dwordx4 v3, s[40:43], s11 offen offset:1024 lds
    s_waitcnt lgkmcnt(4)
    v_mfma_f32_32x32x16_bf16 v[112:127], v[148:151], a[196:199], v[112:127]
    ds_read_b64_tr_b16 v[136:137], v23 offset:4096
    ds_read_b64_tr_b16 v[138:139], v23 offset:4352
    v_add_f32 v99, v243, v99
    v_add_f32 v100, v244, v100
    v_add_f32 v101, v245, v101
    buffer_load_dwordx4 v4, s[40:43], s11 offen offset:2048 lds
    s_waitcnt lgkmcnt(4)
    v_mfma_f32_32x32x16_bf16 v[112:127], v[160:163], a[200:203], v[112:127]
    ds_read_b64_tr_b16 v[148:149], v23 offset:5120
    ds_read_b64_tr_b16 v[150:151], v23 offset:5376
    v_add_f32 v102, v246, v102
    v_add_f32 v103, v247, v103
    v_add_f32 v104, v248, v104
    buffer_load_dwordx4 v5, s[40:43], s11 offen offset:3072 lds
    s_waitcnt lgkmcnt(4)
    v_mfma_f32_32x32x16_bf16 v[112:127], v[172:175], a[204:207], v[112:127]
    ds_read_b64_tr_b16 v[160:161], v23 offset:6144
    ds_read_b64_tr_b16 v[162:163], v23 offset:6400
    v_add_f32 v105, v249, v105
    v_add_f32 v106, v250, v106
    v_add_f32 v107, v251, v107
    s_add_u32 m0, s67, 0
    s_cmp_ge_u32 s10, 8
    s_cselect_b32 s11, -8, 3
    s_lshl_b32 s11, s11, 17
    s_add_u32 s11, s11, s65
    buffer_load_dwordx4 v2, s[40:43], s11 offen offset:0 lds
    s_waitcnt lgkmcnt(4)
    v_mfma_f32_32x32x16_bf16 v[112:127], v[136:139], a[208:211], v[112:127]
    ds_read_b64_tr_b16 v[172:173], v23 offset:7168
    ds_read_b64_tr_b16 v[174:175], v23 offset:7424
    v_add_f32 v108, v252, v108
    v_add_f32 v109, v253, v109
    v_add_f32 v110, v254, v110
    buffer_load_dwordx4 v3, s[40:43], s11 offen offset:1024 lds
    s_waitcnt lgkmcnt(4)
    v_mfma_f32_32x32x16_bf16 v[112:127], v[148:151], a[212:215], v[112:127]
    ds_read_b64_tr_b16 v[136:137], v23 offset:40960
    ds_read_b64_tr_b16 v[138:139], v23 offset:41216
    v_add_f32 v111, v255, v111
    v_add_f32 v96, v24, v96
    v_add_f32 v97, v24, v97
    buffer_load_dwordx4 v4, s[40:43], s11 offen offset:2048 lds
    s_waitcnt lgkmcnt(4)
    v_mfma_f32_32x32x16_bf16 v[112:127], v[160:163], a[216:219], v[112:127]
    ds_read_b64_tr_b16 v[148:149], v23 offset:41984
    ds_read_b64_tr_b16 v[150:151], v23 offset:42240
    v_add_f32 v98, v24, v98
    v_add_f32 v99, v24, v99
    v_add_f32 v100, v24, v100
    buffer_load_dwordx4 v5, s[40:43], s11 offen offset:3072 lds
    s_waitcnt lgkmcnt(4)
    v_mfma_f32_32x32x16_bf16 v[112:127], v[172:175], a[220:223], v[112:127]
    ds_read_b64_tr_b16 v[160:161], v23 offset:43008
    ds_read_b64_tr_b16 v[162:163], v23 offset:43264
    v_add_f32 v101, v24, v101
    v_add_f32 v102, v24, v102
    v_add_f32 v103, v24, v103
    s_add_u32 m0, s67, 4096
    s_cmp_ge_u32 s10, 7
    s_cselect_b32 s11, -7, 4
    s_lshl_b32 s11, s11, 17
    s_add_u32 s11, s11, s65
    buffer_load_dwordx4 v2, s[40:43], s11 offen offset:0 lds
    s_waitcnt lgkmcnt(4)
    v_mfma_f32_32x32x16_bf16 v[112:127], v[136:139], a[224:227], v[112:127]
    ds_read_b64_tr_b16 v[172:173], v23 offset:44032
    ds_read_b64_tr_b16 v[174:175], v23 offset:44288
    v_add_f32 v104, v24, v104
    v_add_f32 v105, v24, v105
    v_add_f32 v106, v24, v106
    buffer_load_dwordx4 v3, s[40:43], s11 offen offset:1024 lds
    s_waitcnt lgkmcnt(4)
    v_mfma_f32_32x32x16_bf16 v[112:127], v[148:151], a[228:231], v[112:127]
    ds_read_b64_tr_b16 v[136:137], v23 offset:45056
    ds_read_b64_tr_b16 v[138:139], v23 offset:45312
    v_add_f32 v107, v24, v107
    v_add_f32 v108, v24, v108
    v_add_f32 v109, v24, v109
    buffer_load_dwordx4 v4, s[40:43], s11 offen offset:2048 lds
    s_waitcnt lgkmcnt(4)
    v_mfma_f32_32x32x16_bf16 v[112:127], v[160:163], a[232:235], v[112:127]
    ds_read_b64_tr_b16 v[148:149], v23 offset:46080
    ds_read_b64_tr_b16 v[150:151], v23 offset:46336
    v_add_f32 v110, v24, v110
    v_add_f32 v111, v24, v111
    v_cvt_pk_bf16_f32 v224, v96, v97
    buffer_load_dwordx4 v5, s[40:43], s11 offen offset:3072 lds
    s_waitcnt lgkmcnt(4)
    v_mfma_f32_32x32x16_bf16 v[112:127], v[172:175], a[236:239], v[112:127]
    ds_read_b64_tr_b16 v[160:161], v23 offset:47104
    ds_read_b64_tr_b16 v[162:163], v23 offset:47360
    v_cvt_pk_bf16_f32 v225, v98, v99
    v_cvt_pk_bf16_f32 v226, v100, v101
    v_cvt_pk_bf16_f32 v227, v102, v103
    s_add_u32 m0, s67, 8192
    s_cmp_ge_u32 s10, 4
    s_cselect_b32 s11, -4, 7
    s_lshl_b32 s11, s11, 17
    s_add_u32 s11, s11, s65
    buffer_load_dwordx4 v2, s[40:43], s11 offen offset:0 lds
    s_waitcnt lgkmcnt(4)
    v_mfma_f32_32x32x16_bf16 v[112:127], v[136:139], a[240:243], v[112:127]
    ds_read_b64_tr_b16 v[172:173], v23 offset:48128
    ds_read_b64_tr_b16 v[174:175], v23 offset:48384
    v_cvt_pk_bf16_f32 v228, v104, v105
    v_cvt_pk_bf16_f32 v229, v106, v107
    v_cvt_pk_bf16_f32 v230, v108, v109
    buffer_load_dwordx4 v3, s[40:43], s11 offen offset:1024 lds
    s_waitcnt lgkmcnt(4)
    v_mfma_f32_32x32x16_bf16 v[112:127], v[148:151], a[244:247], v[112:127]
    v_cvt_pk_bf16_f32 v231, v110, v111
    buffer_load_dwordx4 v4, s[40:43], s11 offen offset:2048 lds
    s_waitcnt lgkmcnt(2)
    v_mfma_f32_32x32x16_bf16 v[112:127], v[160:163], a[248:251], v[112:127]
    buffer_load_dwordx4 v5, s[40:43], s11 offen offset:3072 lds
    s_waitcnt lgkmcnt(0)
    v_mfma_f32_32x32x16_bf16 v[112:127], v[172:175], a[252:255], v[112:127]
    s_add_u32 m0, s67, 12288
    s_cmp_ge_u32 s10, 3
    s_cselect_b32 s11, -3, 8
    s_lshl_b32 s11, s11, 17
    s_add_u32 s11, s11, s65
    buffer_load_dwordx4 v2, s[40:43], s11 offen offset:0 lds
    ds_read_b64_tr_b16 a[0:1], v10 offset:16384
    ds_read_b64_tr_b16 a[2:3], v10 offset:17408
    ds_read_b64_tr_b16 a[4:5], v11 offset:16384
    ds_read_b64_tr_b16 a[6:7], v11 offset:17408
    ds_read_b64_tr_b16 a[8:9], v10 offset:18432
    ds_read_b64_tr_b16 a[10:11], v10 offset:19456
    ds_read_b64_tr_b16 a[12:13], v11 offset:18432
    ds_read_b64_tr_b16 a[14:15], v11 offset:19456
    ds_read_b64_tr_b16 a[16:17], v10 offset:20480
    ds_read_b64_tr_b16 a[18:19], v10 offset:21504
    ds_read_b64_tr_b16 a[20:21], v11 offset:20480
    ds_read_b64_tr_b16 a[22:23], v11 offset:21504
    ds_read_b64_tr_b16 a[24:25], v10 offset:22528
    ds_read_b64_tr_b16 a[26:27], v10 offset:23552
    ds_read_b64_tr_b16 a[28:29], v11 offset:22528
    ds_read_b64_tr_b16 a[30:31], v11 offset:23552
    v_pk_mul_f32 v[240:241], v[112:113], s[60:61] op_sel_hi:[1,0]
    buffer_load_dwordx4 v3, s[40:43], s11 offen offset:1024 lds
    v_pk_mul_f32 v[242:243], v[114:115], s[60:61] op_sel_hi:[1,0]
    v_pk_mul_f32 v[244:245], v[116:117], s[60:61] op_sel_hi:[1,0]
    v_pk_mul_f32 v[246:247], v[118:119], s[60:61] op_sel_hi:[1,0]
    v_pk_mul_f32 v[248:249], v[120:121], s[60:61] op_sel_hi:[1,0]
    v_pk_mul_f32 v[250:251], v[122:123], s[60:61] op_sel_hi:[1,0]
    v_pk_mul_f32 v[252:253], v[124:125], s[60:61] op_sel_hi:[1,0]
    v_pk_mul_f32 v[254:255], v[126:127], s[60:61] op_sel_hi:[1,0]
    v_exp_f32_e64 v240, v240 clamp
    v_max_f32 v112, 0, v112
    buffer_load_dwordx4 v4, s[40:43], s11 offen offset:2048 lds
    v_exp_f32_e64 v241, v241 clamp
    v_max_f32 v113, 0, v113
    v_exp_f32_e64 v242, v242 clamp
    v_max_f32 v114, 0, v114
    v_exp_f32_e64 v243, v243 clamp
    v_max_f32 v115, 0, v115
    v_exp_f32_e64 v244, v244 clamp
    v_max_f32 v116, 0, v116
    v_exp_f32_e64 v245, v245 clamp
    buffer_load_dwordx4 v5, s[40:43], s11 offen offset:3072 lds
    v_max_f32 v117, 0, v117
    v_exp_f32_e64 v246, v246 clamp
    v_max_f32 v118, 0, v118
    v_exp_f32_e64 v247, v247 clamp
    v_max_f32 v119, 0, v119
    v_exp_f32_e64 v248, v248 clamp
    v_max_f32 v120, 0, v120
    v_exp_f32_e64 v249, v249 clamp
    v_max_f32 v121, 0, v121
    s_waitcnt lgkmcnt(8)
    s_add_u32 m0, s67, 16384
    s_cmp_ge_u32 s10, 2
    s_cselect_b32 s11, -2, 9
    s_lshl_b32 s11, s11, 17
    s_add_u32 s11, s11, s65
    buffer_load_dwordx4 v2, s[40:43], s11 offen offset:0 lds
    v_exp_f32_e64 v250, v250 clamp
    v_max_f32 v122, 0, v122
    v_exp_f32_e64 v251, v251 clamp
    v_max_f32 v123, 0, v123
    v_exp_f32_e64 v252, v252 clamp
    v_max_f32 v124, 0, v124
    v_exp_f32_e64 v253, v253 clamp
    v_max_f32 v125, 0, v125
    v_exp_f32_e64 v254, v254 clamp
    buffer_load_dwordx4 v3, s[40:43], s11 offen offset:1024 lds
    v_max_f32 v126, 0, v126
    v_exp_f32_e64 v255, v255 clamp
    v_max_f32 v127, 0, v127
    v_pk_add_f32 v[112:113], v[112:113], v[240:241]
    v_pk_add_f32 v[114:115], v[114:115], v[242:243]
    v_pk_add_f32 v[116:117], v[116:117], v[244:245]
    v_pk_add_f32 v[118:119], v[118:119], v[246:247]
    v_pk_add_f32 v[120:121], v[120:121], v[248:249]
    v_pk_add_f32 v[122:123], v[122:123], v[250:251]
    buffer_load_dwordx4 v4, s[40:43], s11 offen offset:2048 lds
    v_pk_add_f32 v[124:125], v[124:125], v[252:253]
    v_pk_add_f32 v[126:127], v[126:127], v[254:255]
    v_pk_add_f32 v[112:113], v[112:113], v[24:25] op_sel_hi:[1,0]
    v_pk_add_f32 v[114:115], v[114:115], v[24:25] op_sel_hi:[1,0]
    v_pk_add_f32 v[116:117], v[116:117], v[24:25] op_sel_hi:[1,0]
    v_pk_add_f32 v[118:119], v[118:119], v[24:25] op_sel_hi:[1,0]
    v_pk_add_f32 v[120:121], v[120:121], v[24:25] op_sel_hi:[1,0]
    v_pk_add_f32 v[122:123], v[122:123], v[24:25] op_sel_hi:[1,0]
    v_pk_add_f32 v[124:125], v[124:125], v[24:25] op_sel_hi:[1,0]
    buffer_load_dwordx4 v5, s[40:43], s11 offen offset:3072 lds
    v_pk_add_f32 v[126:127], v[126:127], v[24:25] op_sel_hi:[1,0]
    v_cvt_pk_bf16_f32 v232, v112, v113
    v_cvt_pk_bf16_f32 v233, v114, v115
    v_cvt_pk_bf16_f32 v234, v116, v117
    v_cvt_pk_bf16_f32 v235, v118, v119
    v_cvt_pk_bf16_f32 v236, v120, v121
    v_cvt_pk_bf16_f32 v237, v122, v123
    v_cvt_pk_bf16_f32 v238, v124, v125
    v_cvt_pk_bf16_f32 v239, v126, v127
    buffer_load_dwordx2 v[30:31], v26, s[28:31], 0 offen sc1
    s_waitcnt lgkmcnt(0)
    s_add_u32 m0, s67, 20480
    s_cmp_ge_u32 s10, 1
    s_cselect_b32 s11, -1, 10
    s_lshl_b32 s11, s11, 17
    s_add_u32 s11, s11, s65
    buffer_load_dwordx4 v2, s[40:43], s11 offen offset:0 lds
    buffer_load_dwordx4 v3, s[40:43], s11 offen offset:1024 lds
    buffer_load_dwordx4 v4, s[40:43], s11 offen offset:2048 lds
    buffer_load_dwordx4 v5, s[40:43], s11 offen offset:3072 lds
    s_waitcnt vmcnt(25)
    ds_read_b64_tr_b16 a[32:33], v10 offset:36864
    ds_read_b64_tr_b16 a[34:35], v10 offset:37888
    ds_read_b64_tr_b16 a[36:37], v11 offset:36864
    ds_read_b64_tr_b16 a[38:39], v11 offset:37888
    ds_read_b64_tr_b16 a[40:41], v10 offset:38912
    ds_read_b64_tr_b16 a[42:43], v10 offset:39936
    ds_read_b64_tr_b16 a[44:45], v11 offset:38912
    ds_read_b64_tr_b16 a[46:47], v11 offset:39936
    s_waitcnt vmcnt(21)
    ds_read_b64_tr_b16 a[48:49], v10 offset:0
    ds_read_b64_tr_b16 a[50:51], v10 offset:1024
    ds_read_b64_tr_b16 a[52:53], v11 offset:0
    ds_read_b64_tr_b16 a[54:55], v11 offset:1024
    ds_read_b64_tr_b16 a[56:57], v10 offset:2048
    ds_read_b64_tr_b16 a[58:59], v10 offset:3072
    ds_read_b64_tr_b16 a[60:61], v11 offset:2048
    ds_read_b64_tr_b16 a[62:63], v11 offset:3072
    s_waitcnt vmcnt(17)
    ds_read_b64_tr_b16 a[64:65], v10 offset:4096
    ds_read_b64_tr_b16 a[66:67], v10 offset:5120
    ds_read_b64_tr_b16 a[68:69], v11 offset:4096
    ds_read_b64_tr_b16 a[70:71], v11 offset:5120
    ds_read_b64_tr_b16 a[72:73], v10 offset:6144
    ds_read_b64_tr_b16 a[74:75], v10 offset:7168
    ds_read_b64_tr_b16 a[76:77], v11 offset:6144
    ds_read_b64_tr_b16 a[78:79], v11 offset:7168
    s_waitcnt vmcnt(4)
    v_cmp_ne_u64 vcc, s[26:27], v[30:31]
    s_nop 0
    s_cbranch_vccz L_ok1
    s_mov_b32 s77, 0
L_spin1:
    s_sleep 1
    buffer_load_dwordx2 v[30:31], v26, s[28:31], 0 offen sc1
    s_add_u32 s77, s77, 1
    s_cmp_ge_u32 s77, 0x10000
    s_waitcnt vmcnt(0)
    s_cbranch_scc1 L_ok1
    v_cmp_ne_u64 vcc, s[26:27], v[30:31]
    s_nop 0
    s_cbranch_vccnz L_spin1
L_ok1:
    buffer_load_dwordx4 v[32:35], v27, s[28:31], s72 offen offset:0 sc1
    buffer_load_dwordx4 v[36:39], v27, s[28:31], s72 offen offset:1024 sc1
    s_add_u32 s72, s72, 65536
    buffer_load_dwordx4 v[40:43], v27, s[28:31], s72 offen offset:0 sc1
    buffer_load_dwordx4 v[44:47], v27, s[28:31], s72 offen offset:1024 sc1
    s_add_u32 s72, s72, 65536
    buffer_load_dwordx4 v[48:51], v27, s[28:31], s72 offen offset:0 sc1
    buffer_load_dwordx4 v[52:55], v27, s[28:31], s72 offen offset:1024 sc1
    s_add_u32 s72, s72, 65536
    buffer_load_dwordx4 v[56:59], v27, s[28:31], s72 offen offset:0 sc1
    buffer_load_dwordx4 v[60:63], v27, s[28:31], s72 offen offset:1024 sc1
    s_waitcnt lgkmcnt(8)
    s_add_u32 m0, s67, 0
    s_cmp_ge_u32 s10, 6
    s_cselect_b32 s11, -6, 5
    s_lshl_b32 s11, s11, 17
    s_add_u32 s11, s11, s65
    buffer_load_dwordx4 v2, s[40:43], s11 offen offset:0 lds
    buffer_load_dwordx4 v3, s[40:43], s11 offen offset:1024 lds
    buffer_load_dwordx4 v4, s[40:43], s11 offen offset:2048 lds
    buffer_load_dwordx4 v5, s[40:43], s11 offen offset:3072 lds
    s_waitcnt lgkmcnt(0)
    s_add_u32 m0, s67, 4096
    s_cmp_ge_u32 s10, 5
    s_cselect_b32 s11, -5, 6
    s_lshl_b32 s11, s11, 17
    s_add_u32 s11, s11, s65
    buffer_load_dwordx4 v2, s[40:43], s11 offen offset:0 lds
    buffer_load_dwordx4 v3, s[40:43], s11 offen offset:1024 lds
    buffer_load_dwordx4 v4, s[40:43], s11 offen offset:2048 lds
    buffer_load_dwordx4 v5, s[40:43], s11 offen offset:3072 lds
    s_waitcnt vmcnt(13)
    v_pk_add_f32 v[32:33], v[32:33], v[40:41]
    v_pk_add_f32 v[34:35], v[34:35], v[42:43]
    s_waitcnt vmcnt(12)
    v_pk_add_f32 v[36:37], v[36:37], v[44:45]
    v_pk_add_f32 v[38:39], v[38:39], v[46:47]
    s_waitcnt vmcnt(9)
    v_pk_add_f32 v[48:49], v[48:49], v[56:57]
    v_pk_add_f32 v[50:51], v[50:51], v[58:59]
    s_waitcnt vmcnt(8)
    v_pk_add_f32 v[52:53], v[52:53], v[60:61]
    v_pk_add_f32 v[54:55], v[54:55], v[62:63]
    v_pk_add_f32 v[32:33], v[32:33], v[48:49]
    v_pk_add_f32 v[34:35], v[34:35], v[50:51]
    v_pk_add_f32 v[36:37], v[36:37], v[52:53]
    v_pk_add_f32 v[38:39], v[38:39], v[54:55]
    s_barrier
    ds_write_b128 v18, v[32:35] offset:0
    ds_write_b128 v18, v[36:39] offset:1024
    s_lshl_b32 s72, s70, 16
    s_lshl_b32 s59, s58, 11
    s_add_u32 s72, s72, s59
    s_add_u32 s72, s72, 0x500000
    s_add_u32 s73, s72, 32768
    s_lshl4_add_u32 s74, s70, s58
    s_lshl_b32 s74, s74, 7
    s_add_u32 s74, s74, 0x60000
    s_waitcnt lgkmcnt(0)
    s_barrier
    ds_read_b128 v[32:35], v19 offset:0
    ds_read_b128 v[36:39], v19 offset:1024
    ds_read_b128 v[40:43], v20 offset:0
    ds_read_b128 v[44:47], v20 offset:1024
    ds_read_b128 v[48:51], v19 offset:40960
    ds_read_b128 v[52:55], v19 offset:41984
    ds_read_b128 v[56:59], v20 offset:40960
    ds_read_b128 v[60:63], v20 offset:41984
    s_waitcnt lgkmcnt(5)
    v_pk_add_f32 v[32:33], v[32:33], v[40:41]
    v_pk_add_f32 v[34:35], v[34:35], v[42:43]
    s_waitcnt lgkmcnt(4)
    v_pk_add_f32 v[36:37], v[36:37], v[44:45]
    v_pk_add_f32 v[38:39], v[38:39], v[46:47]
    v_cvt_pk_bf16_f32 v208, v32, v33
    v_cvt_pk_bf16_f32 v209, v34, v35
    v_cvt_pk_bf16_f32 v210, v36, v37
    v_cvt_pk_bf16_f32 v211, v38, v39
    s_nop 1
    v_mfma_f32_32x32x16_bf16 v[64:79], v[208:211], v[224:227], 0
    v_mfma_f32_32x32x16_bf16 v[80:95], v[208:211], v[232:235], 0
    s_waitcnt lgkmcnt(1)
    v_pk_add_f32 v[48:49], v[48:49], v[56:57]
    v_pk_add_f32 v[50:51], v[50:51], v[58:59]
    s_waitcnt lgkmcnt(0)
    v_pk_add_f32 v[52:53], v[52:53], v[60:61]
    v_pk_add_f32 v[54:55], v[54:55], v[62:63]
    v_cvt_pk_bf16_f32 v212, v48, v49
    v_cvt_pk_bf16_f32 v213, v50, v51
    v_cvt_pk_bf16_f32 v214, v52, v53
    v_cvt_pk_bf16_f32 v215, v54, v55
    s_nop 1
    v_mfma_f32_32x32x16_bf16 v[96:111], v[212:215], v[228:231], 0
    v_mfma_f32_32x32x16_bf16 v[112:127], v[212:215], v[236:239], 0
    s_barrier
    v_add_f32 v72, v24, v72
    v_rcp_f32 v72, v72
    s_nop 0
    v_pk_mul_f32 v[64:65], v[64:65], v[72:73] op_sel_hi:[1,0]
    v_pk_mul_f32 v[66:67], v[66:67], v[72:73] op_sel_hi:[1,0]
    v_pk_mul_f32 v[68:69], v[68:69], v[72:73] op_sel_hi:[1,0]
    v_pk_mul_f32 v[70:71], v[70:71], v[72:73] op_sel_hi:[1,0]
    v_cvt_pk_bf16_f32 v76, v64, v65
    v_cvt_pk_bf16_f32 v77, v66, v67
    v_cvt_pk_bf16_f32 v78, v68, v69
    v_cvt_pk_bf16_f32 v79, v70, v71
    buffer_store_dwordx4 v[76:79], v27, s[28:31], s72 offen offset:0 sc1
    v_add_f32 v88, v24, v88
    v_rcp_f32 v88, v88
    s_nop 0
    v_pk_mul_f32 v[80:81], v[80:81], v[88:89] op_sel_hi:[1,0]
    v_pk_mul_f32 v[82:83], v[82:83], v[88:89] op_sel_hi:[1,0]
    v_pk_mul_f32 v[84:85], v[84:85], v[88:89] op_sel_hi:[1,0]
    v_pk_mul_f32 v[86:87], v[86:87], v[88:89] op_sel_hi:[1,0]
    v_cvt_pk_bf16_f32 v92, v80, v81
    v_cvt_pk_bf16_f32 v93, v82, v83
    v_cvt_pk_bf16_f32 v94, v84, v85
    v_cvt_pk_bf16_f32 v95, v86, v87
    buffer_store_dwordx4 v[92:95], v27, s[28:31], s73 offen offset:0 sc1
    v_add_f32 v96, v24, v96
    v_rcp_f32 v96, v96
    s_nop 0
    v_pk_mul_f32 v[104:105], v[104:105], v[96:97] op_sel_hi:[1,0]
    v_pk_mul_f32 v[106:107], v[106:107], v[96:97] op_sel_hi:[1,0]
    v_pk_mul_f32 v[108:109], v[108:109], v[96:97] op_sel_hi:[1,0]
    v_pk_mul_f32 v[110:111], v[110:111], v[96:97] op_sel_hi:[1,0]
    v_cvt_pk_bf16_f32 v100, v104, v105
    v_cvt_pk_bf16_f32 v101, v106, v107
    v_cvt_pk_bf16_f32 v102, v108, v109
    v_cvt_pk_bf16_f32 v103, v110, v111
    buffer_store_dwordx4 v[100:103], v27, s[28:31], s72 offen offset:1024 sc1
    v_add_f32 v112, v24, v112
    v_rcp_f32 v112, v112
    s_nop 0
    v_pk_mul_f32 v[120:121], v[120:121], v[112:113] op_sel_hi:[1,0]
    v_pk_mul_f32 v[122:123], v[122:123], v[112:113] op_sel_hi:[1,0]
    v_pk_mul_f32 v[124:125], v[124:125], v[112:113] op_sel_hi:[1,0]
    v_pk_mul_f32 v[126:127], v[126:127], v[112:113] op_sel_hi:[1,0]
    v_cvt_pk_bf16_f32 v116, v120, v121
    v_cvt_pk_bf16_f32 v117, v122, v123
    v_cvt_pk_bf16_f32 v118, v124, v125
    v_cvt_pk_bf16_f32 v119, v126, v127
    buffer_store_dwordx4 v[116:119], v27, s[28:31], s73 offen offset:1024 sc1
    s_mov_b32 s76, s74
    s_mov_b64 s[48:49], s[18:19]
    s_mov_b32 s50, 0x1000
    s_mov_b32 s51, 0x20000
    v_lshrrev_b32 v24, 2, v0
    v_and_b32 v25, 3, v0
    v_lshlrev_b32 v22, 4, v25
    v_lshl_add_u32 v23, v24, 10, v22
    s_and_b32 s70, s55, 0
    s_lshl_b32 s70, s70, 6
    v_xor_b32 v23, s70, v23
    v_xor_b32 v233, 64, v23
    v_xor_b32 v12, s70, v12
    v_xor_b32 v13, s70, v13
    v_lshlrev_b32 v22, 1, v24
    s_lshl_b32 s69, s55, 16
    s_lshl_b32 s59, s56, 7
    s_add_u32 s69, s69, s59
    s_lshl_b32 s59, s55, 7
    buffer_load_dwordx4 v[248:251], v23, s[32:35], s69 offen
    buffer_load_dwordx4 v[252:255], v233, s[32:35], s69 offen
    buffer_load_ushort v232, v22, s[48:51], s59 offen
    v_xor_b32 v25, v24, v25
    v_and_b32 v25, 7, v25
    v_lshlrev_b32 v25, 4, v25
    v_and_b32 v24, 31, v24
    v_lshl_add_u32 v22, v24, 7, v25
    v_lshrrev_b32 v24, 5, v1
    v_and_b32 v25, 31, v1
    v_lshlrev_b32 v25, 7, v25
    v_lshl_add_u32 v24, v24, 12, v25
    v_and_b32 v25, 7, v1
    v_lshl_add_u32 v24, v25, 4, v24
    v_add_u32 v14, s67, v24
    v_xor_b32 v15, 16, v14
    v_xor_b32 v16, 32, v14
    v_xor_b32 v17, 48, v14
    v_xor_b32 v18, 64, v14
    v_xor_b32 v19, 80, v14
    v_xor_b32 v20, 96, v14
    v_xor_b32 v21, 112, v14
    s_lshl2_add_u32 s59, s56, s3
    s_lshl_b32 s59, s59, 11
    s_add_u32 s59, s59, 0x50000
    v_lshrrev_b32 v24, 2, v1
    v_lshlrev_b32 v24, 7, v24
    v_add_u32 v26, s59, v24
    s_mul_i32 s71, s3, 360448
    s_lshl_b32 s59, s56, 11
    s_add_u32 s71, s71, s59
    s_add_u32 s71, s71, 0x700400
    s_lshl_b32 s59, s70, 4
    s_xor_b32 s71, s71, s59
    s_add_u32 s75, s71, 360448
    s_mov_b32 s74, s71
    s_lshl_b32 s59, s10, 15
    s_add_u32 s71, s71, s59
    s_mov_b32 s72, s71
    s_lshr_b32 s62, s3, 1
    s_lshl1_add_u32 s59, s55, s62
    s_lshl_b32 s59, s59, 10
    s_add_u32 s59, s59, 0x60000
    v_lshrrev_b32 v24, 3, v1
    v_lshlrev_b32 v24, 7, v24
    v_add_u32 v25, s59, v24
    s_and_b32 s59, s3, 1
    s_lshl1_add_u32 s59, s55, s59
    s_lshl1_add_u32 s59, s59, s62
    s_lshl_b32 s73, s59, 14
    s_add_u32 s73, s73, 0x500000
    s_mov_b32 s60, 0xbfb8aa3b
    s_waitcnt vmcnt(3)
    s_mov_b64 exec, 1
    buffer_store_dwordx2 v[28:29], off, s[28:31], s76 sc1
    s_mov_b64 exec, -1
    s_branch L_ys
L_u:
    s_load_dwordx2 s[26:27], s[24:25], 0
    s_mov_b64 s[28:29], s[24:25]
    s_mov_b32 s30, 0x858000
    s_mov_b32 s31, 0x20000
    s_and_b32 s59, s54, 0x1c
    s_lshr_b32 s59, 0x73546210, s59
    s_and_b32 s59, s59, 7
    s_lshl3_add_u32 s55, s53, s59
    s_and_b32 s59, s54, 3
    s_lshl2_add_u32 s56, s52, s59
    s_mov_b64 s[32:33], s[4:5]
    s_mov_b32 s34, 0x200000
    s_mov_b32 s35, 0x20000
    s_mov_b64 s[48:49], s[14:15]
    s_mov_b32 s50, 0xac0
    s_mov_b32 s51, 0x20000
    s_lshl_b32 s59, s78, 6
    v_lshlrev_b32 v20, 1, v0
    v_mov_b32 v21, 0x7fffff00
    v_cmp_gt_u32 vcc, 32, v0
    s_nop 1
    v_cndmask_b32 v20, v21, v20, vcc
    buffer_load_ushort v128, v20, s[48:51], s59 offen offset:0
    buffer_load_ushort v132, v20, s[48:51], s59 offen offset:64
    buffer_load_ushort v136, v20, s[48:51], s59 offen offset:128
    v_lshrrev_b32 v18, 5, v1
    v_bfe_u32 v19, v1, 2, 2
    v_lshl_add_u32 v19, v18, 3, v19
    v_mul_u32_u24 v17, 192, v19
    v_bfe_u32 v19, v1, 4, 1
    s_lshr_b32 s59, s3, 1
    v_xor_b32 v19, s59, v19
    v_lshl_add_u32 v17, v19, 5, v17
    v_and_b32 v19, 3, v1
    v_lshl_add_u32 v17, v19, 3, v17
    v_add_u32 v17, s70, v17
    v_and_b32 v19, 31, v1
    v_lshlrev_b32 v19, 4, v19
    v_lshl_add_u32 v18, v18, 13, v19
    s_and_b32 s59, s3, 1
    s_lshl1_add_u32 s59, s57, s59
    s_lshl_b32 s59, s59, 9
    s_lshl_b32 s62, s3, 19
    s_add_u32 s59, s59, s62
    s_add_u32 s59, s59, 0x300000
    v_add_u32 v18, s59, v18
    v_xor_b32 v19, 512, v18
    s_and_b32 s59, s57, 3
    s_lshl2_add_u32 s59, s59, s3
    s_lshl_b32 s59, s59, 12
    s_add_u32 s59, s59, 0x30000
    v_lshrrev_b32 v26, 1, v1
    v_lshl_add_u32 v26, v26, 7, s59
    s_mov_b64 s[40:41], s[16:17]
    s_mov_b32 s42, 0x560000
    s_mov_b32 s43, 0x20000
    s_mov_b64 s[44:45], s[8:9]
    s_mov_b32 s46, 0x80000
    s_mov_b32 s47, 0x20000
    v_lshrrev_b32 v10, 3, v1
    v_bfe_u32 v11, v1, 4, 1
    v_lshlrev_b32 v11, 2, v11
    v_and_b32 v12, 7, v1
    v_xor_b32 v11, v11, v12
    v_lshlrev_b32 v11, 4, v11
    v_lshl_add_u32 v2, v10, 12, v11
    v_lshl_add_u32 v6, v10, 10, v11
    v_add_u32 v3, 31744, v2
    v_add_u32 v7, 7168, v6
    v_add_u32 v4, 31744, v3
    v_add_u32 v8, 7168, v7
    v_add_u32 v5, 31744, v4
    v_add_u32 v9, 7168, v8
    s_mul_i32 s65, s3, 1441792
    s_lshl_b32 s59, s55, 7
    s_add_u32 s65, s65, s59
    s_and_b32 s10, s56, 3
    s_mul_i32 s10, s10, 3
    s_lshl_b32 s59, s10, 17
    s_add_u32 s65, s65, s59
    s_lshl_b32 s66, s3, 17
    s_lshl_b32 s59, s56, 7
    s_add_u32 s66, s66, s59
    s_mul_i32 s67, s3, 40960
    v_lshrrev_b32 v10, 5, v1
    v_bfe_u32 v11, v1, 2, 2
    v_lshl_add_u32 v10, v10, 2, v11
    v_lshlrev_b32 v10, 7, v10
    v_bfe_u32 v11, v1, 3, 1
    v_lshl_add_u32 v10, v11, 6, v10
    v_bfe_u32 v11, v1, 4, 1
    v_lshl_add_u32 v10, v11, 5, v10
    v_and_b32 v11, 3, v1
    v_lshl_add_u32 v10, v11, 3, v10
    s_lshr_b32 s59, s3, 1
    s_mul_i32 s59, s59, 81920
    s_add_u32 s59, s59, 24576
    v_add_u32 v12, s59, v10
    v_xor_b32 v13, 64, v12
    v_add_u32 v10, s67, v10
    v_xor_b32 v11, 64, v10
    v_add_u32 v20, s70, v27
    s_xor_b32 s59, s3, 1
    s_mul_i32 s59, s59, 40960
    v_add_u32 v21, s59, v27
    s_xor_b32 s59, s3, 2
    s_mul_i32 s59, s59, 40960
    v_add_u32 v22, s59, v27
    s_xor_b32 s59, s3, 3
    s_mul_i32 s59, s59, 40960
    v_add_u32 v23, s59, v27
    s_lshl_b32 s74, s78, 1
    s_lshr_b32 s59, s3, 1
    s_add_u32 s74, s74, s59
    s_and_b32 s59, s3, 1
    s_lshl1_add_u32 s59, s57, s59
    s_lshl4_add_u32 s74, s74, s59
    s_lshl_b32 s74, s74, 10
    s_add_u32 s74, s74, 0x700000
    s_add_u32 s75, s74, 32768
    s_add_u32 s76, s74, 65536
    s_cmp_eq_u32 s79, 8
    s_cselect_b32 s76, 0x7f000000, s76
    s_mov_b32 s60, 0xbdd2d3e8
    v_mov_b32 v24, 0xc0135761
    s_add_u32 m0, s70, 6144
    s_nop 0
    buffer_load_dwordx4 v14, s[36:39], s69 offen offset:0  lds
    buffer_load_dwordx4 v15, s[36:39], s69 offen offset:1024  lds
    buffer_load_dwordx4 v16, s[36:39], s69 offen offset:2048  lds
    s_add_u32 s69, s69, 44032
    s_add_u32 m0, s70, 9216
    s_nop 0
    buffer_load_dwordx4 v14, s[36:39], s69 offen offset:0  lds
    buffer_load_dwordx4 v15, s[36:39], s69 offen offset:1024  lds
    buffer_load_dwordx4 v16, s[36:39], s69 offen offset:2048  lds
    s_add_u32 s64, s71, 2
    s_and_b32 s64, s64, 7
    s_mul_i32 s69, s64, 88064
    s_add_u32 m0, s70, 12288
    s_nop 0
    buffer_load_dwordx4 v14, s[36:39], s69 offen offset:0  lds
    buffer_load_dwordx4 v15, s[36:39], s69 offen offset:1024  lds
    buffer_load_dwordx4 v16, s[36:39], s69 offen offset:2048  lds
    s_add_u32 s69, s69, 44032
    s_add_u32 m0, s70, 15360
    s_nop 0
    buffer_load_dwordx4 v14, s[36:39], s69 offen offset:0  lds
    buffer_load_dwordx4 v15, s[36:39], s69 offen offset:1024  lds
    buffer_load_dwordx4 v16, s[36:39], s69 offen offset:2048  lds
    s_bitcmp1_b32 s57, 0
    s_cselect_b32 s63, 3, 8
    s_add_u32 s64, s71, s63
    s_and_b32 s64, s64, 7
    s_and_b32 s63, s63, 8
    s_or_b32 s64, s64, s63
    s_mul_i32 s69, s64, 88064
    s_add_u32 m0, s70, 18432
    s_nop 0
    buffer_load_dwordx4 v14, s[36:39], s69 offen offset:0  lds
    buffer_load_dwordx4 v15, s[36:39], s69 offen offset:1024  lds
    buffer_load_dwordx4 v16, s[36:39], s69 offen offset:2048  lds
    s_add_u32 s69, s69, 44032
    s_add_u32 m0, s70, 21504
    s_nop 0
    buffer_load_dwordx4 v14, s[36:39], s69 offen offset:0  lds
    buffer_load_dwordx4 v15, s[36:39], s69 offen offset:1024  lds
    buffer_load_dwordx4 v16, s[36:39], s69 offen offset:2048  lds
    s_bitcmp1_b32 s57, 0
    s_cselect_b32 s63, 4, 3
    s_add_u32 s64, s71, s63
    s_and_b32 s64, s64, 7
    s_mul_i32 s69, s64, 88064
    s_add_u32 m0, s70, 24576
    s_nop 0
    buffer_load_dwordx4 v14, s[36:39], s69 offen offset:0  lds
    buffer_load_dwordx4 v15, s[36:39], s69 offen offset:1024  lds
    buffer_load_dwordx4 v16, s[36:39], s69 offen offset:2048  lds
    s_add_u32 s69, s69, 44032
    s_add_u32 m0, s70, 27648
    s_nop 0
    buffer_load_dwordx4 v14, s[36:39], s69 offen offset:0  lds
    buffer_load_dwordx4 v15, s[36:39], s69 offen offset:1024  lds
    buffer_load_dwordx4 v16, s[36:39], s69 offen offset:2048  lds
    s_bitcmp1_b32 s57, 0
    s_cselect_b32 s63, 5, 4
    s_add_u32 s64, s71, s63
    s_and_b32 s64, s64, 7
    s_mul_i32 s69, s64, 88064
    s_add_u32 m0, s70, 30720
    s_nop 0
    buffer_load_dwordx4 v14, s[36:39], s69 offen offset:0  lds
    buffer_load_dwordx4 v15, s[36:39], s69 offen offset:1024  lds
    buffer_load_dwordx4 v16, s[36:39], s69 offen offset:2048  lds
    s_add_u32 s69, s69, 44032
    s_add_u32 m0, s70, 33792
    s_nop 0
    buffer_load_dwordx4 v14, s[36:39], s69 offen offset:0  lds
    buffer_load_dwordx4 v15, s[36:39], s69 offen offset:1024  lds
    buffer_load_dwordx4 v16, s[36:39], s69 offen offset:2048  lds
    s_bitcmp1_b32 s57, 0
    s_cselect_b32 s63, 8, 5
    s_add_u32 s64, s71, s63
    s_and_b32 s64, s64, 7
    s_and_b32 s63, s63, 8
    s_or_b32 s64, s64, s63
    s_mul_i32 s69, s64, 88064
    s_add_u32 m0, s70, 36864
    s_nop 0
    buffer_load_dwordx4 v14, s[36:39], s69 offen offset:0  lds
    buffer_load_dwordx4 v15, s[36:39], s69 offen offset:1024  lds
    buffer_load_dwordx4 v16, s[36:39], s69 offen offset:2048  lds
    s_add_u32 s69, s69, 44032
    v_mov_b32 v129, 0
    v_mov_b32 v130, 0
    v_mov_b32 v131, 0
    v_mov_b32 v133, 0
    v_mov_b32 v134, 0
    v_mov_b32 v135, 0
    v_mov_b32 v137, 0
    v_mov_b32 v138, 0
    v_mov_b32 v139, 0
    v_mov_b32 v140, 0x3f80
    v_mov_b32 v141, 0
    v_mov_b32 v142, 0
    v_mov_b32 v143, 0
    s_waitcnt vmcnt(35)
    s_nop 0
    v_mfma_f32_32x32x16_bf16 v[32:47], v[128:131], v[140:143], 0
    v_mfma_f32_32x32x16_bf16 v[48:63], v[128:131], v[140:143], 0
    s_waitcnt vmcnt(34)
    v_mfma_f32_32x32x16_bf16 v[64:79], v[132:135], v[140:143], 0
    v_mfma_f32_32x32x16_bf16 v[80:95], v[132:135], v[140:143], 0
    s_waitcnt vmcnt(33)
    v_mfma_f32_32x32x16_bf16 v[96:111], v[136:139], v[140:143], 0
    v_mfma_f32_32x32x16_bf16 v[112:127], v[136:139], v[140:143], 0
    s_waitcnt lgkmcnt(0)
    s_add_u32 s26, s26, 0x9e3779b9
    s_addc_u32 s27, s27, 0x7f4a7c15
    v_mov_b32 v28, s26
    v_mov_b32 v29, s27
    ds_read_b64_tr_b16 a[0:1], v17 offset:0
    ds_read_b64_tr_b16 a[2:3], v17 offset:768
    ds_read_b64_tr_b16 a[4:5], v17 offset:64
    ds_read_b64_tr_b16 a[6:7], v17 offset:832
    ds_read_b64_tr_b16 a[8:9], v17 offset:128
    ds_read_b64_tr_b16 a[10:11], v17 offset:896
    ds_read_b64_tr_b16 a[12:13], v17 offset:3072
    ds_read_b64_tr_b16 a[14:15], v17 offset:3840
    ds_read_b64_tr_b16 a[16:17], v17 offset:3136
    ds_read_b64_tr_b16 a[18:19], v17 offset:3904
    ds_read_b64_tr_b16 a[20:21], v17 offset:3200
    ds_read_b64_tr_b16 a[22:23], v17 offset:3968
    s_waitcnt lgkmcnt(6)
    s_add_u32 m0, s70, 0
    s_nop 0
    buffer_load_dwordx4 v14, s[36:39], s69 offen offset:0  lds
    buffer_load_dwordx4 v15, s[36:39], s69 offen offset:1024  lds
    buffer_load_dwordx4 v16, s[36:39], s69 offen offset:2048  lds
    s_add_u32 s64, s71, 6
    s_and_b32 s64, s64, 7
    s_mul_i32 s69, s64, 88064
    s_waitcnt vmcnt(33)
    ds_read_b64_tr_b16 a[24:25], v17 offset:6144
    ds_read_b64_tr_b16 a[26:27], v17 offset:6912
    ds_read_b64_tr_b16 a[28:29], v17 offset:6208
    ds_read_b64_tr_b16 a[30:31], v17 offset:6976
    ds_read_b64_tr_b16 a[32:33], v17 offset:6272
    ds_read_b64_tr_b16 a[34:35], v17 offset:7040
    s_waitcnt lgkmcnt(6)
    s_add_u32 m0, s70, 3072
    s_nop 0
    buffer_load_dwordx4 v14, s[36:39], s69 offen offset:0  lds
    buffer_load_dwordx4 v15, s[36:39], s69 offen offset:1024  lds
    buffer_load_dwordx4 v16, s[36:39], s69 offen offset:2048  lds
    s_add_u32 s69, s69, 44032
    s_waitcnt vmcnt(33)
    ds_read_b64_tr_b16 a[36:37], v17 offset:9216
    ds_read_b64_tr_b16 a[38:39], v17 offset:9984
    ds_read_b64_tr_b16 a[40:41], v17 offset:9280
    ds_read_b64_tr_b16 a[42:43], v17 offset:10048
    ds_read_b64_tr_b16 a[44:45], v17 offset:9344
    ds_read_b64_tr_b16 a[46:47], v17 offset:10112
    s_waitcnt lgkmcnt(6)
    s_add_u32 m0, s70, 6144
    s_nop 0
    buffer_load_dwordx4 v14, s[36:39], s69 offen offset:0  lds
    buffer_load_dwordx4 v15, s[36:39], s69 offen offset:1024  lds
    buffer_load_dwordx4 v16, s[36:39], s69 offen offset:2048  lds
    s_add_u32 s64, s71, 7
    s_and_b32 s64, s64, 7
    s_mul_i32 s69, s64, 88064
    s_waitcnt vmcnt(33)
    ds_read_b64_tr_b16 a[48:49], v17 offset:12288
    ds_read_b64_tr_b16 a[50:51], v17 offset:13056
    ds_read_b64_tr_b16 a[52:53], v17 offset:12352
    ds_read_b64_tr_b16 a[54:55], v17 offset:13120
    ds_read_b64_tr_b16 a[56:57], v17 offset:12416
    ds_read_b64_tr_b16 a[58:59], v17 offset:13184
    s_waitcnt lgkmcnt(6)
    s_add_u32 m0, s70, 9216
    s_nop 0
    buffer_load_dwordx4 v14, s[36:39], s69 offen offset:0  lds
    buffer_load_dwordx4 v15, s[36:39], s69 offen offset:1024  lds
    buffer_load_dwordx4 v16, s[36:39], s69 offen offset:2048  lds
    s_add_u32 s69, s69, 44032
    s_waitcnt vmcnt(33)
    ds_read_b64_tr_b16 a[60:61], v17 offset:15360
    ds_read_b64_tr_b16 a[62:63], v17 offset:16128
    ds_read_b64_tr_b16 a[64:65], v17 offset:15424
    ds_read_b64_tr_b16 a[66:67], v17 offset:16192
    ds_read_b64_tr_b16 a[68:69], v17 offset:15488
    ds_read_b64_tr_b16 a[70:71], v17 offset:16256
    buffer_load_dwordx2 v[30:31], v26, s[28:31], 0 offen sc1
    s_waitcnt lgkmcnt(6)
    s_add_u32 m0, s70, 12288
    s_nop 0
    buffer_load_dwordx4 v14, s[36:39], s69 offen offset:0  lds
    buffer_load_dwordx4 v15, s[36:39], s69 offen offset:1024  lds
    buffer_load_dwordx4 v16, s[36:39], s69 offen offset:2048  lds
    s_add_u32 s64, s71, 1
    s_and_b32 s64, s64, 7
    s_or_b32 s64, s64, 8
    s_mul_i32 s69, s64, 88064
    s_waitcnt vmcnt(34)
    ds_read_b64_tr_b16 a[72:73], v17 offset:18432
    ds_read_b64_tr_b16 a[74:75], v17 offset:19200
    ds_read_b64_tr_b16 a[76:77], v17 offset:18496
    ds_read_b64_tr_b16 a[78:79], v17 offset:19264
    ds_read_b64_tr_b16 a[80:81], v17 offset:18560
    ds_read_b64_tr_b16 a[82:83], v17 offset:19328
    s_waitcnt lgkmcnt(6)
    s_add_u32 m0, s70, 15360
    s_nop 0
    buffer_load_dwordx4 v14, s[36:39], s69 offen offset:0  lds
    buffer_load_dwordx4 v15, s[36:39], s69 offen offset:1024  lds
    buffer_load_dwordx4 v16, s[36:39], s69 offen offset:2048  lds
    s_add_u32 s69, s69, 44032
    s_waitcnt vmcnt(34)
    ds_read_b64_tr_b16 a[84:85], v17 offset:21504
    ds_read_b64_tr_b16 a[86:87], v17 offset:22272
    ds_read_b64_tr_b16 a[88:89], v17 offset:21568
    ds_read_b64_tr_b16 a[90:91], v17 offset:22336
    ds_read_b64_tr_b16 a[92:93], v17 offset:21632
    ds_read_b64_tr_b16 a[94:95], v17 offset:22400
    s_waitcnt lgkmcnt(6)
    s_add_u32 m0, s70, 18432
    s_nop 0
    buffer_load_dwordx4 v14, s[36:39], s69 offen offset:0  lds
    buffer_load_dwordx4 v15, s[36:39], s69 offen offset:1024  lds
    buffer_load_dwordx4 v16, s[36:39], s69 offen offset:2048  lds
    s_add_u32 s64, s71, 2
    s_and_b32 s64, s64, 7
    s_or_b32 s64, s64, 8
    s_mul_i32 s69, s64, 88064
    s_waitcnt vmcnt(34)
    ds_read_b64_tr_b16 a[96:97], v17 offset:24576
    ds_read_b64_tr_b16 a[98:99], v17 offset:25344
    ds_read_b64_tr_b16 a[100:101], v17 offset:24640
    ds_read_b64_tr_b16 a[102:103], v17 offset:25408
    ds_read_b64_tr_b16 a[104:105], v17 offset:24704
    ds_read_b64_tr_b16 a[106:107], v17 offset:25472
    s_waitcnt vmcnt(31)
    ds_read_b64_tr_b16 a[108:109], v17 offset:27648
    ds_read_b64_tr_b16 a[110:111], v17 offset:28416
    ds_read_b64_tr_b16 a[112:113], v17 offset:27712
    ds_read_b64_tr_b16 a[114:115], v17 offset:28480
    ds_read_b64_tr_b16 a[116:117], v17 offset:27776
    ds_read_b64_tr_b16 a[118:119], v17 offset:28544
    s_waitcnt vmcnt(28)
    ds_read_b64_tr_b16 a[120:121], v17 offset:30720
    ds_read_b64_tr_b16 a[122:123], v17 offset:31488
    ds_read_b64_tr_b16 a[124:125], v17 offset:30784
    ds_read_b64_tr_b16 a[126:127], v17 offset:31552
    ds_read_b64_tr_b16 a[128:129], v17 offset:30848
    ds_read_b64_tr_b16 a[130:131], v17 offset:31616
    s_waitcnt vmcnt(25)
    ds_read_b64_tr_b16 a[132:133], v17 offset:33792
    ds_read_b64_tr_b16 a[134:135], v17 offset:34560
    ds_read_b64_tr_b16 a[136:137], v17 offset:33856
    ds_read_b64_tr_b16 a[138:139], v17 offset:34624
    ds_read_b64_tr_b16 a[140:141], v17 offset:33920
    ds_read_b64_tr_b16 a[142:143], v17 offset:34688
    s_waitcnt vmcnt(22)
    ds_read_b64_tr_b16 a[144:145], v17 offset:36864
    ds_read_b64_tr_b16 a[146:147], v17 offset:37632
    ds_read_b64_tr_b16 a[148:149], v17 offset:36928
    ds_read_b64_tr_b16 a[150:151], v17 offset:37696
    ds_read_b64_tr_b16 a[152:153], v17 offset:36992
    ds_read_b64_tr_b16 a[154:155], v17 offset:37760
    s_waitcnt vmcnt(19)
    ds_read_b64_tr_b16 a[156:157], v17 offset:0
    ds_read_b64_tr_b16 a[158:159], v17 offset:768
    ds_read_b64_tr_b16 a[160:161], v17 offset:64
    ds_read_b64_tr_b16 a[162:163], v17 offset:832
    ds_read_b64_tr_b16 a[164:165], v17 offset:128
    ds_read_b64_tr_b16 a[166:167], v17 offset:896
    s_waitcnt vmcnt(16)
    ds_read_b64_tr_b16 a[168:169], v17 offset:3072
    ds_read_b64_tr_b16 a[170:171], v17 offset:3840
    ds_read_b64_tr_b16 a[172:173], v17 offset:3136
    ds_read_b64_tr_b16 a[174:175], v17 offset:3904
    ds_read_b64_tr_b16 a[176:177], v17 offset:3200
    ds_read_b64_tr_b16 a[178:179], v17 offset:3968
    s_waitcnt vmcnt(13)
    ds_read_b64_tr_b16 a[180:181], v17 offset:6144
    ds_read_b64_tr_b16 a[182:183], v17 offset:6912
    ds_read_b64_tr_b16 a[184:185], v17 offset:6208
    ds_read_b64_tr_b16 a[186:187], v17 offset:6976
    ds_read_b64_tr_b16 a[188:189], v17 offset:6272
    ds_read_b64_tr_b16 a[190:191], v17 offset:7040
    s_waitcnt vmcnt(9)
    v_cmp_ne_u64 vcc, s[26:27], v[30:31]
    s_nop 0
    s_cbranch_vccz L_ok2
    s_mov_b32 s77, 0
L_spin2:
    s_sleep 1
    buffer_load_dwordx2 v[30:31], v26, s[28:31], 0 offen sc1
    s_add_u32 s77, s77, 1
    s_cmp_ge_u32 s77, 0x10000
    s_waitcnt vmcnt(0)
    s_cbranch_scc1 L_ok2
    v_cmp_ne_u64 vcc, s[26:27], v[30:31]
    s_nop 0
    s_cbranch_vccnz L_spin2
L_ok2:
    buffer_load_dwordx4 v[192:195], v19, s[28:31], s73 offen sc1
    s_add_u32 s73, s73, 16384
    buffer_load_dwordx4 v[196:199], v19, s[28:31], s73 offen sc1
    s_add_u32 s64, s71, 1
    s_and_b32 s64, s64, 7
    s_lshl_b32 s73, s64, 15
    buffer_load_dwordx4 v[200:203], v19, s[28:31], s73 offen sc1
    s_add_u32 s73, s73, 16384
    buffer_load_dwordx4 v[204:207], v19, s[28:31], s73 offen sc1
    s_add_u32 s64, s71, 2
    s_and_b32 s64, s64, 7
    s_lshl_b32 s73, s64, 15
    buffer_load_dwordx4 v[208:211], v19, s[28:31], s73 offen sc1
    s_add_u32 s73, s73, 16384
    s_waitcnt vmcnt(4)
    v_mfma_f32_32x32x16_bf16 v[48:63], a[0:3], v[192:195], v[48:63]
    buffer_load_dwordx4 v[212:215], v19, s[28:31], s73 offen sc1
    s_bitcmp1_b32 s57, 0
    s_cselect_b32 s63, 3, 8
    s_add_u32 s64, s71, s63
    s_and_b32 s64, s64, 7
    s_and_b32 s63, s63, 8
    s_or_b32 s64, s64, s63
    s_lshl_b32 s73, s64, 15
    s_waitcnt lgkmcnt(14)
    s_add_u32 m0, s70, 21504
    s_nop 0
    buffer_load_dwordx4 v14, s[36:39], s69 offen offset:0  lds
    buffer_load_dwordx4 v15, s[36:39], s69 offen offset:1024  lds
    buffer_load_dwordx4 v16, s[36:39], s69 offen offset:2048  lds
    s_add_u32 s69, s69, 44032
    v_mfma_f32_32x32x16_bf16 v[80:95], a[4:7], v[192:195], v[80:95]
    ds_read_b64_tr_b16 a[192:193], v17 offset:9216
    ds_read_b64_tr_b16 a[194:195], v17 offset:9984
    ds_read_b64_tr_b16 a[196:197], v17 offset:9280
    v_mfma_f32_32x32x16_bf16 v[112:127], a[8:11], v[192:195], v[112:127]
    ds_read_b64_tr_b16 a[198:199], v17 offset:10048
    ds_read_b64_tr_b16 a[200:201], v17 offset:9344
    ds_read_b64_tr_b16 a[202:203], v17 offset:10112
    s_waitcnt vmcnt(7)
    v_mfma_f32_32x32x16_bf16 v[48:63], a[12:15], v[196:199], v[48:63]
    buffer_load_dwordx4 v[216:219], v19, s[28:31], s73 offen sc1
    s_add_u32 s73, s73, 16384
    buffer_load_dwordx4 v[128:131], v18, s[28:31], s72 offen sc1
    s_add_u32 s72, s72, 16384
    ds_read_b64_tr_b16 a[204:205], v17 offset:12288
    v_mfma_f32_32x32x16_bf16 v[80:95], a[16:19], v[196:199], v[80:95]
    ds_read_b64_tr_b16 a[206:207], v17 offset:13056
    ds_read_b64_tr_b16 a[208:209], v17 offset:12352
    ds_read_b64_tr_b16 a[210:211], v17 offset:13120
    v_mfma_f32_32x32x16_bf16 v[112:127], a[20:23], v[196:199], v[112:127]
    ds_read_b64_tr_b16 a[212:213], v17 offset:12416
    ds_read_b64_tr_b16 a[214:215], v17 offset:13184
    s_waitcnt vmcnt(8)
    v_mfma_f32_32x32x16_bf16 v[48:63], a[24:27], v[200:203], v[48:63]
    buffer_load_dwordx4 v[220:223], v19, s[28:31], s73 offen sc1
    s_bitcmp1_b32 s57, 0
    s_cselect_b32 s63, 4, 3
    s_add_u32 s64, s71, s63
    s_and_b32 s64, s64, 7
    s_lshl_b32 s73, s64, 15
    buffer_load_dwordx4 v[132:135], v18, s[28:31], s72 offen sc1
    s_add_u32 s64, s71, 1
    s_and_b32 s64, s64, 7
    s_lshl_b32 s72, s64, 15
    s_add_u32 m0, s70, 24576
    s_nop 0
    buffer_load_dwordx4 v14, s[36:39], s69 offen offset:0  lds
    buffer_load_dwordx4 v15, s[36:39], s69 offen offset:1024  lds
    v_mfma_f32_32x32x16_bf16 v[80:95], a[28:31], v[200:203], v[80:95]
    buffer_load_dwordx4 v16, s[36:39], s69 offen offset:2048  lds
    s_add_u32 s64, s71, 3
    s_and_b32 s64, s64, 7
    s_or_b32 s64, s64, 8
    s_mul_i32 s69, s64, 88064
    ds_read_b64_tr_b16 a[216:217], v17 offset:15360
    ds_read_b64_tr_b16 a[218:219], v17 offset:16128
    ds_read_b64_tr_b16 a[220:221], v17 offset:15424
    v_mfma_f32_32x32x16_bf16 v[112:127], a[32:35], v[200:203], v[112:127]
    ds_read_b64_tr_b16 a[222:223], v17 offset:16192
    ds_read_b64_tr_b16 a[224:225], v17 offset:15488
    ds_read_b64_tr_b16 a[226:227], v17 offset:16256
    s_waitcnt vmcnt(12)
    v_mfma_f32_32x32x16_bf16 v[48:63], a[36:39], v[204:207], v[48:63]
    buffer_load_dwordx4 v[224:227], v19, s[28:31], s73 offen sc1
    s_add_u32 s73, s73, 16384
    buffer_load_dwordx4 v[136:139], v18, s[28:31], s72 offen sc1
    s_add_u32 s72, s72, 16384
    ds_read_b64_tr_b16 a[228:229], v17 offset:18432
    v_mfma_f32_32x32x16_bf16 v[80:95], a[40:43], v[204:207], v[80:95]
    ds_read_b64_tr_b16 a[230:231], v17 offset:19200
    ds_read_b64_tr_b16 a[232:233], v17 offset:18496
    ds_read_b64_tr_b16 a[234:235], v17 offset:19264
    v_mfma_f32_32x32x16_bf16 v[112:127], a[44:47], v[204:207], v[112:127]
    ds_read_b64_tr_b16 a[236:237], v17 offset:18560
    ds_read_b64_tr_b16 a[238:239], v17 offset:19328
    s_waitcnt vmcnt(13)
    v_mfma_f32_32x32x16_bf16 v[48:63], a[48:51], v[208:211], v[48:63]
    buffer_load_dwordx4 v[228:231], v19, s[28:31], s73 offen sc1
    s_bitcmp1_b32 s57, 0
    s_cselect_b32 s63, 5, 4
    s_add_u32 s64, s71, s63
    s_and_b32 s64, s64, 7
    s_lshl_b32 s73, s64, 15
    buffer_load_dwordx4 v[140:143], v18, s[28:31], s72 offen sc1
    s_add_u32 s64, s71, 2
    s_and_b32 s64, s64, 7
    s_lshl_b32 s72, s64, 15
    v_mfma_f32_32x32x16_bf16 v[80:95], a[52:55], v[208:211], v[80:95]
    s_add_u32 m0, s70, 27648
    s_nop 0
    buffer_load_dwordx4 v14, s[36:39], s69 offen offset:0  lds
    buffer_load_dwordx4 v15, s[36:39], s69 offen offset:1024  lds
    v_mfma_f32_32x32x16_bf16 v[112:127], a[56:59], v[208:211], v[112:127]
    buffer_load_dwordx4 v16, s[36:39], s69 offen offset:2048  lds
    s_add_u32 s69, s69, 44032
    s_waitcnt vmcnt(17)
    v_mfma_f32_32x32x16_bf16 v[48:63], a[60:63], v[212:215], v[48:63]
    buffer_load_dwordx4 v[232:235], v19, s[28:31], s73 offen sc1
    s_add_u32 s73, s73, 16384
    buffer_load_dwordx4 v[144:147], v18, s[28:31], s72 offen sc1
    s_add_u32 s72, s72, 16384
    s_waitcnt vmcnt(16)
    ds_read_b64_tr_b16 a[240:241], v17 offset:21504
    v_mfma_f32_32x32x16_bf16 v[80:95], a[64:67], v[212:215], v[80:95]
    ds_read_b64_tr_b16 a[242:243], v17 offset:22272
    ds_read_b64_tr_b16 a[244:245], v17 offset:21568
    ds_read_b64_tr_b16 a[246:247], v17 offset:22336
    v_mfma_f32_32x32x16_bf16 v[112:127], a[68:71], v[212:215], v[112:127]
    ds_read_b64_tr_b16 a[248:249], v17 offset:21632
    ds_read_b64_tr_b16 a[250:251], v17 offset:22400
    s_waitcnt vmcnt(15)
    v_mfma_f32_32x32x16_bf16 v[48:63], a[72:75], v[216:219], v[48:63]
    buffer_load_dwordx4 v[236:239], v19, s[28:31], s73 offen sc1
    s_bitcmp1_b32 s57, 0
    s_cselect_b32 s63, 8, 5
    s_add_u32 s64, s71, s63
    s_and_b32 s64, s64, 7
    s_and_b32 s63, s63, 8
    s_or_b32 s64, s64, s63
    s_lshl_b32 s73, s64, 15
    v_mfma_f32_32x32x16_bf16 v[80:95], a[76:79], v[216:219], v[80:95]
    buffer_load_dwordx4 v[148:151], v18, s[28:31], s72 offen sc1
    s_bitcmp1_b32 s57, 0
    s_cselect_b32 s63, 3, 8
    s_add_u32 s64, s71, s63
    s_and_b32 s64, s64, 7
    s_and_b32 s63, s63, 8
    s_or_b32 s64, s64, s63
    s_lshl_b32 s72, s64, 15
    v_mfma_f32_32x32x16_bf16 v[112:127], a[80:83], v[216:219], v[112:127]
    s_add_u32 m0, s70, 30720
    s_nop 0
    buffer_load_dwordx4 v14, s[36:39], s69 offen offset:0  lds
    s_waitcnt vmcnt(17)
    v_mfma_f32_32x32x16_bf16 v[32:47], a[0:3], v[128:131], v[32:47]
    buffer_load_dwordx4 v15, s[36:39], s69 offen offset:1024  lds
    v_mfma_f32_32x32x16_bf16 v[64:79], a[4:7], v[128:131], v[64:79]
    buffer_load_dwordx4 v16, s[36:39], s69 offen offset:2048  lds
    s_add_u32 s64, s71, 4
    s_and_b32 s64, s64, 7
    s_or_b32 s64, s64, 8
    s_mul_i32 s69, s64, 88064
    v_mfma_f32_32x32x16_bf16 v[96:111], a[8:11], v[128:131], v[96:111]
    s_waitcnt vmcnt(18)
    v_mfma_f32_32x32x16_bf16 v[48:63], a[84:87], v[220:223], v[48:63]
    buffer_load_dwordx4 v[240:243], v19, s[28:31], s73 offen sc1
    s_add_u32 s73, s73, 16384
    buffer_load_dwordx4 v[152:155], v18, s[28:31], s72 offen sc1
    s_add_u32 s72, s72, 16384
    v_mfma_f32_32x32x16_bf16 v[80:95], a[88:91], v[220:223], v[80:95]
    s_waitcnt vmcnt(16)
    ds_read_b64_tr_b16 a[0:1], v17 offset:24576
    v_mfma_f32_32x32x16_bf16 v[112:127], a[92:95], v[220:223], v[112:127]
    ds_read_b64_tr_b16 a[2:3], v17 offset:25344
    v_mfma_f32_32x32x16_bf16 v[32:47], a[12:15], v[132:135], v[32:47]
    ds_read_b64_tr_b16 a[4:5], v17 offset:24640
    ds_read_b64_tr_b16 a[6:7], v17 offset:25408
    v_mfma_f32_32x32x16_bf16 v[64:79], a[16:19], v[132:135], v[64:79]
    ds_read_b64_tr_b16 a[8:9], v17 offset:24704
    v_mfma_f32_32x32x16_bf16 v[96:111], a[20:23], v[132:135], v[96:111]
    ds_read_b64_tr_b16 a[10:11], v17 offset:25472
    s_waitcnt vmcnt(15)
    v_mfma_f32_32x32x16_bf16 v[48:63], a[96:99], v[224:227], v[48:63]
    buffer_load_dwordx4 v[244:247], v19, s[28:31], s73 offen sc1
    s_add_u32 s64, s71, 6
    s_and_b32 s64, s64, 7
    s_lshl_b32 s73, s64, 15
    v_mfma_f32_32x32x16_bf16 v[80:95], a[100:103], v[224:227], v[80:95]
    buffer_load_dwordx4 v[156:159], v18, s[28:31], s72 offen sc1
    s_bitcmp1_b32 s57, 0
    s_cselect_b32 s63, 4, 3
    s_add_u32 s64, s71, s63
    s_and_b32 s64, s64, 7
    s_lshl_b32 s72, s64, 15
    v_mfma_f32_32x32x16_bf16 v[112:127], a[104:107], v[224:227], v[112:127]
    s_add_u32 m0, s70, 33792
    s_nop 0
    buffer_load_dwordx4 v14, s[36:39], s69 offen offset:0  lds
    s_waitcnt vmcnt(17)
    v_mfma_f32_32x32x16_bf16 v[32:47], a[24:27], v[136:139], v[32:47]
    buffer_load_dwordx4 v15, s[36:39], s69 offen offset:1024  lds
    v_mfma_f32_32x32x16_bf16 v[64:79], a[28:31], v[136:139], v[64:79]
    buffer_load_dwordx4 v16, s[36:39], s69 offen offset:2048  lds
    s_add_u32 s69, s69, 44032
    v_mfma_f32_32x32x16_bf16 v[96:111], a[32:35], v[136:139], v[96:111]
    s_waitcnt vmcnt(18)
    v_mfma_f32_32x32x16_bf16 v[48:63], a[108:111], v[228:231], v[48:63]
    buffer_load_dwordx4 v[248:251], v19, s[28:31], s73 offen sc1
    s_add_u32 s73, s73, 16384
    buffer_load_dwordx4 v[160:163], v18, s[28:31], s72 offen sc1
    s_add_u32 s72, s72, 16384
    v_mfma_f32_32x32x16_bf16 v[80:95], a[112:115], v[228:231], v[80:95]
    s_waitcnt vmcnt(16)
    ds_read_b64_tr_b16 a[12:13], v17 offset:27648
    v_mfma_f32_32x32x16_bf16 v[112:127], a[116:119], v[228:231], v[112:127]
    ds_read_b64_tr_b16 a[14:15], v17 offset:28416
    v_mfma_f32_32x32x16_bf16 v[32:47], a[36:39], v[140:143], v[32:47]
    ds_read_b64_tr_b16 a[16:17], v17 offset:27712
    ds_read_b64_tr_b16 a[18:19], v17 offset:28480
    v_mfma_f32_32x32x16_bf16 v[64:79], a[40:43], v[140:143], v[64:79]
    ds_read_b64_tr_b16 a[20:21], v17 offset:27776
    v_mfma_f32_32x32x16_bf16 v[96:111], a[44:47], v[140:143], v[96:111]
    ds_read_b64_tr_b16 a[22:23], v17 offset:28544
    s_waitcnt vmcnt(15)
    v_mfma_f32_32x32x16_bf16 v[48:63], a[120:123], v[232:235], v[48:63]
    buffer_load_dwordx4 v[252:255], v19, s[28:31], s73 offen sc1
    s_add_u32 s64, s71, 7
    s_and_b32 s64, s64, 7
    s_lshl_b32 s73, s64, 15
    v_mfma_f32_32x32x16_bf16 v[80:95], a[124:127], v[232:235], v[80:95]
    buffer_load_dwordx4 v[164:167], v18, s[28:31], s72 offen sc1
    s_bitcmp1_b32 s57, 0
    s_cselect_b32 s63, 5, 4
    s_add_u32 s64, s71, s63
    s_and_b32 s64, s64, 7
    s_lshl_b32 s72, s64, 15
    v_mfma_f32_32x32x16_bf16 v[112:127], a[128:131], v[232:235], v[112:127]
    s_add_u32 m0, s70, 36864
    s_nop 0
    buffer_load_dwordx4 v14, s[36:39], s69 offen offset:0  lds
    s_waitcnt vmcnt(17)
    v_mfma_f32_32x32x16_bf16 v[32:47], a[48:51], v[144:147], v[32:47]
    buffer_load_dwordx4 v15, s[36:39], s69 offen offset:1024  lds
    v_mfma_f32_32x32x16_bf16 v[64:79], a[52:55], v[144:147], v[64:79]
    buffer_load_dwordx4 v16, s[36:39], s69 offen offset:2048  lds
    s_add_u32 s64, s71, 5
    s_and_b32 s64, s64, 7
    s_or_b32 s64, s64, 8
    s_mul_i32 s69, s64, 88064
    v_mfma_f32_32x32x16_bf16 v[96:111], a[56:59], v[144:147], v[96:111]
    s_waitcnt vmcnt(18)
    v_mfma_f32_32x32x16_bf16 v[48:63], a[132:135], v[236:239], v[48:63]
    buffer_load_dwordx4 v[192:195], v19, s[28:31], s73 offen sc1
    s_add_u32 s73, s73, 16384
    buffer_load_dwordx4 v[168:171], v18, s[28:31], s72 offen sc1
    s_add_u32 s72, s72, 16384
    v_mfma_f32_32x32x16_bf16 v[80:95], a[136:139], v[236:239], v[80:95]
    s_waitcnt vmcnt(16)
    ds_read_b64_tr_b16 a[24:25], v17 offset:30720
    v_mfma_f32_32x32x16_bf16 v[112:127], a[140:143], v[236:239], v[112:127]
    ds_read_b64_tr_b16 a[26:27], v17 offset:31488
    v_mfma_f32_32x32x16_bf16 v[32:47], a[60:63], v[148:151], v[32:47]
    ds_read_b64_tr_b16 a[28:29], v17 offset:30784
    ds_read_b64_tr_b16 a[30:31], v17 offset:31552
    v_mfma_f32_32x32x16_bf16 v[64:79], a[64:67], v[148:151], v[64:79]
    ds_read_b64_tr_b16 a[32:33], v17 offset:30848
    v_mfma_f32_32x32x16_bf16 v[96:111], a[68:71], v[148:151], v[96:111]
    ds_read_b64_tr_b16 a[34:35], v17 offset:31616
    s_waitcnt vmcnt(15)
    v_mfma_f32_32x32x16_bf16 v[48:63], a[144:147], v[240:243], v[48:63]
    buffer_load_dwordx4 v[196:199], v19, s[28:31], s73 offen sc1
    s_add_u32 s64, s71, 1
    s_and_b32 s64, s64, 7
    s_or_b32 s64, s64, 8
    s_lshl_b32 s73, s64, 15
    v_mfma_f32_32x32x16_bf16 v[80:95], a[148:151], v[240:243], v[80:95]
    buffer_load_dwordx4 v[172:175], v18, s[28:31], s72 offen sc1
    s_bitcmp1_b32 s57, 0
    s_cselect_b32 s63, 8, 5
    s_add_u32 s64, s71, s63
    s_and_b32 s64, s64, 7
    s_and_b32 s63, s63, 8
    s_or_b32 s64, s64, s63
    s_lshl_b32 s72, s64, 15
    v_mfma_f32_32x32x16_bf16 v[112:127], a[152:155], v[240:243], v[112:127]
    s_waitcnt lgkmcnt(14)
    s_add_u32 m0, s70, 0
    s_nop 0
    buffer_load_dwordx4 v14, s[36:39], s69 offen offset:0  lds
    s_waitcnt vmcnt(17)
    v_mfma_f32_32x32x16_bf16 v[32:47], a[72:75], v[152:155], v[32:47]
    buffer_load_dwordx4 v15, s[36:39], s69 offen offset:1024  lds
    v_mfma_f32_32x32x16_bf16 v[64:79], a[76:79], v[152:155], v[64:79]
    buffer_load_dwordx4 v16, s[36:39], s69 offen offset:2048  lds
    s_add_u32 s69, s69, 44032
    v_mfma_f32_32x32x16_bf16 v[96:111], a[80:83], v[152:155], v[96:111]
    s_waitcnt vmcnt(18)
    v_mfma_f32_32x32x16_bf16 v[48:63], a[156:159], v[244:247], v[48:63]
    buffer_load_dwordx4 v[200:203], v19, s[28:31], s73 offen sc1
    s_add_u32 s73, s73, 16384
    buffer_load_dwordx4 v[176:179], v18, s[28:31], s72 offen sc1
    s_add_u32 s72, s72, 16384
    v_mfma_f32_32x32x16_bf16 v[80:95], a[160:163], v[244:247], v[80:95]
    s_waitcnt vmcnt(16)
    ds_read_b64_tr_b16 a[36:37], v17 offset:33792
    v_mfma_f32_32x32x16_bf16 v[112:127], a[164:167], v[244:247], v[112:127]
    ds_read_b64_tr_b16 a[38:39], v17 offset:34560
    v_mfma_f32_32x32x16_bf16 v[32:47], a[84:87], v[156:159], v[32:47]
    ds_read_b64_tr_b16 a[40:41], v17 offset:33856
    ds_read_b64_tr_b16 a[42:43], v17 offset:34624
    v_mfma_f32_32x32x16_bf16 v[64:79], a[88:91], v[156:159], v[64:79]
    ds_read_b64_tr_b16 a[44:45], v17 offset:33920
    v_mfma_f32_32x32x16_bf16 v[96:111], a[92:95], v[156:159], v[96:111]
    ds_read_b64_tr_b16 a[46:47], v17 offset:34688
    s_waitcnt vmcnt(15)
    v_mfma_f32_32x32x16_bf16 v[48:63], a[168:171], v[248:251], v[48:63]
    buffer_load_dwordx4 v[204:207], v19, s[28:31], s73 offen sc1
    s_add_u32 s64, s71, 2
    s_and_b32 s64, s64, 7
    s_or_b32 s64, s64, 8
    s_lshl_b32 s73, s64, 15
    v_mfma_f32_32x32x16_bf16 v[80:95], a[172:175], v[248:251], v[80:95]
    buffer_load_dwordx4 v[180:183], v18, s[28:31], s72 offen sc1
    s_add_u32 s64, s71, 6
    s_and_b32 s64, s64, 7
    s_lshl_b32 s72, s64, 15
    v_mfma_f32_32x32x16_bf16 v[112:127], a[176:179], v[248:251], v[112:127]
    s_add_u32 m0, s70, 3072
    s_nop 0
    buffer_load_dwordx4 v14, s[36:39], s69 offen offset:0  lds
    s_waitcnt vmcnt(17)
    v_mfma_f32_32x32x16_bf16 v[32:47], a[96:99], v[160:163], v[32:47]
    buffer_load_dwordx4 v15, s[36:39], s69 offen offset:1024  lds
    v_mfma_f32_32x32x16_bf16 v[64:79], a[100:103], v[160:163], v[64:79]
    buffer_load_dwordx4 v16, s[36:39], s69 offen offset:2048  lds
    s_add_u32 s64, s71, 6
    s_and_b32 s64, s64, 7
    s_or_b32 s64, s64, 8
    s_mul_i32 s69, s64, 88064
    v_mfma_f32_32x32x16_bf16 v[96:111], a[104:107], v[160:163], v[96:111]
    s_waitcnt vmcnt(18)
    v_mfma_f32_32x32x16_bf16 v[48:63], a[180:183], v[252:255], v[48:63]
    buffer_load_dwordx4 v[208:211], v19, s[28:31], s73 offen sc1
    s_add_u32 s73, s73, 16384
    buffer_load_dwordx4 v[184:187], v18, s[28:31], s72 offen sc1
    s_add_u32 s72, s72, 16384
    v_mfma_f32_32x32x16_bf16 v[80:95], a[184:187], v[252:255], v[80:95]
    s_waitcnt vmcnt(16)
    ds_read_b64_tr_b16 a[48:49], v17 offset:36864
    v_mfma_f32_32x32x16_bf16 v[112:127], a[188:191], v[252:255], v[112:127]
    ds_read_b64_tr_b16 a[50:51], v17 offset:37632
    v_mfma_f32_32x32x16_bf16 v[32:47], a[108:111], v[164:167], v[32:47]
    ds_read_b64_tr_b16 a[52:53], v17 offset:36928
    ds_read_b64_tr_b16 a[54:55], v17 offset:37696
    v_mfma_f32_32x32x16_bf16 v[64:79], a[112:115], v[164:167], v[64:79]
    ds_read_b64_tr_b16 a[56:57], v17 offset:36992
    v_mfma_f32_32x32x16_bf16 v[96:111], a[116:119], v[164:167], v[96:111]
    ds_read_b64_tr_b16 a[58:59], v17 offset:37760
    s_waitcnt vmcnt(15)
    v_mfma_f32_32x32x16_bf16 v[48:63], a[192:195], v[192:195], v[48:63]
    buffer_load_dwordx4 v[212:215], v19, s[28:31], s73 offen sc1
    s_add_u32 s64, s71, 3
    s_and_b32 s64, s64, 7
    s_or_b32 s64, s64, 8
    s_lshl_b32 s73, s64, 15
    v_mfma_f32_32x32x16_bf16 v[80:95], a[196:199], v[192:195], v[80:95]
    buffer_load_dwordx4 v[188:191], v18, s[28:31], s72 offen sc1
    s_add_u32 s64, s71, 7
    s_and_b32 s64, s64, 7
    s_lshl_b32 s72, s64, 15
    v_mfma_f32_32x32x16_bf16 v[112:127], a[200:203], v[192:195], v[112:127]
    s_add_u32 m0, s70, 6144
    s_nop 0
    buffer_load_dwordx4 v14, s[36:39], s69 offen offset:0  lds
    s_waitcnt vmcnt(17)
    v_mfma_f32_32x32x16_bf16 v[32:47], a[120:123], v[168:171], v[32:47]
    buffer_load_dwordx4 v15, s[36:39], s69 offen offset:1024  lds
    v_mfma_f32_32x32x16_bf16 v[64:79], a[124:127], v[168:171], v[64:79]
    buffer_load_dwordx4 v16, s[36:39], s69 offen offset:2048  lds
    s_add_u32 s69, s69, 44032
    v_mfma_f32_32x32x16_bf16 v[96:111], a[128:131], v[168:171], v[96:111]
    s_waitcnt vmcnt(18)
    v_mfma_f32_32x32x16_bf16 v[48:63], a[204:207], v[196:199], v[48:63]
    buffer_load_dwordx4 v[216:219], v19, s[28:31], s73 offen sc1
    s_add_u32 s73, s73, 16384
    buffer_load_dwordx4 v[128:131], v18, s[28:31], s72 offen sc1
    s_add_u32 s72, s72, 16384
    v_mfma_f32_32x32x16_bf16 v[80:95], a[208:211], v[196:199], v[80:95]
    s_waitcnt vmcnt(16)
    ds_read_b64_tr_b16 a[60:61], v17 offset:0
    v_mfma_f32_32x32x16_bf16 v[112:127], a[212:215], v[196:199], v[112:127]
    ds_read_b64_tr_b16 a[62:63], v17 offset:768
    v_mfma_f32_32x32x16_bf16 v[32:47], a[132:135], v[172:175], v[32:47]
    ds_read_b64_tr_b16 a[64:65], v17 offset:64
    ds_read_b64_tr_b16 a[66:67], v17 offset:832
    v_mfma_f32_32x32x16_bf16 v[64:79], a[136:139], v[172:175], v[64:79]
    ds_read_b64_tr_b16 a[68:69], v17 offset:128
    v_mfma_f32_32x32x16_bf16 v[96:111], a[140:143], v[172:175], v[96:111]
    ds_read_b64_tr_b16 a[70:71], v17 offset:896
    s_waitcnt vmcnt(15)
    v_mfma_f32_32x32x16_bf16 v[48:63], a[216:219], v[200:203], v[48:63]
    buffer_load_dwordx4 v[220:223], v19, s[28:31], s73 offen sc1
    s_add_u32 s64, s71, 4
    s_and_b32 s64, s64, 7
    s_or_b32 s64, s64, 8
    s_lshl_b32 s73, s64, 15
    v_mfma_f32_32x32x16_bf16 v[80:95], a[220:223], v[200:203], v[80:95]
    buffer_load_dwordx4 v[132:135], v18, s[28:31], s72 offen sc1
    s_add_u32 s64, s71, 1
    s_and_b32 s64, s64, 7
    s_or_b32 s64, s64, 8
    s_lshl_b32 s72, s64, 15
    v_mfma_f32_32x32x16_bf16 v[112:127], a[224:227], v[200:203], v[112:127]
    s_add_u32 m0, s70, 9216
    s_nop 0
    buffer_load_dwordx4 v14, s[36:39], s69 offen offset:0  lds
    s_waitcnt vmcnt(17)
    v_mfma_f32_32x32x16_bf16 v[32:47], a[144:147], v[176:179], v[32:47]
    buffer_load_dwordx4 v15, s[36:39], s69 offen offset:1024  lds
    v_mfma_f32_32x32x16_bf16 v[64:79], a[148:151], v[176:179], v[64:79]
    buffer_load_dwordx4 v16, s[36:39], s69 offen offset:2048  lds
    s_add_u32 s64, s71, 7
    s_and_b32 s64, s64, 7
    s_or_b32 s64, s64, 8
    s_mul_i32 s69, s64, 88064
    v_mfma_f32_32x32x16_bf16 v[96:111], a[152:155], v[176:179], v[96:111]
    s_waitcnt vmcnt(18)
    v_mfma_f32_32x32x16_bf16 v[48:63], a[228:231], v[204:207], v[48:63]
    buffer_load_dwordx4 v[224:227], v19, s[28:31], s73 offen sc1
    s_add_u32 s73, s73, 16384
    buffer_load_dwordx4 v[136:139], v18, s[28:31], s72 offen sc1
    s_add_u32 s72, s72, 16384
    v_mfma_f32_32x32x16_bf16 v[80:95], a[232:235], v[204:207], v[80:95]
    s_waitcnt vmcnt(16)
    ds_read_b64_tr_b16 a[72:73], v17 offset:3072
    v_mfma_f32_32x32x16_bf16 v[112:127], a[236:239], v[204:207], v[112:127]
    ds_read_b64_tr_b16 a[74:75], v17 offset:3840
    v_mfma_f32_32x32x16_bf16 v[32:47], a[156:159], v[180:183], v[32:47]
    ds_read_b64_tr_b16 a[76:77], v17 offset:3136
    ds_read_b64_tr_b16 a[78:79], v17 offset:3904
    v_mfma_f32_32x32x16_bf16 v[64:79], a[160:163], v[180:183], v[64:79]
    ds_read_b64_tr_b16 a[80:81], v17 offset:3200
    v_mfma_f32_32x32x16_bf16 v[96:111], a[164:167], v[180:183], v[96:111]
    ds_read_b64_tr_b16 a[82:83], v17 offset:3968
    s_waitcnt vmcnt(15)
    v_mfma_f32_32x32x16_bf16 v[48:63], a[240:243], v[208:211], v[48:63]
    buffer_load_dwordx4 v[228:231], v19, s[28:31], s73 offen sc1
    s_add_u32 s64, s71, 5
    s_and_b32 s64, s64, 7
    s_or_b32 s64, s64, 8
    s_lshl_b32 s73, s64, 15
    v_mfma_f32_32x32x16_bf16 v[80:95], a[244:247], v[208:211], v[80:95]
    buffer_load_dwordx4 v[140:143], v18, s[28:31], s72 offen sc1
    s_add_u32 s64, s71, 2
    s_and_b32 s64, s64, 7
    s_or_b32 s64, s64, 8
    s_lshl_b32 s72, s64, 15
    v_mfma_f32_32x32x16_bf16 v[112:127], a[248:251], v[208:211], v[112:127]
    s_add_u32 m0, s70, 12288
    s_nop 0
    buffer_load_dwordx4 v14, s[36:39], s69 offen offset:0  lds
    s_waitcnt vmcnt(17)
    v_mfma_f32_32x32x16_bf16 v[32:47], a[168:171], v[184:187], v[32:47]
    buffer_load_dwordx4 v15, s[36:39], s69 offen offset:1024  lds
    v_mfma_f32_32x32x16_bf16 v[64:79], a[172:175], v[184:187], v[64:79]
    buffer_load_dwordx4 v16, s[36:39], s69 offen offset:2048  lds
    s_add_u32 s69, s69, 44032
    v_mfma_f32_32x32x16_bf16 v[96:111], a[176:179], v[184:187], v[96:111]
    s_waitcnt vmcnt(18)
    v_mfma_f32_32x32x16_bf16 v[48:63], a[0:3], v[212:215], v[48:63]
    buffer_load_dwordx4 v[232:235], v19, s[28:31], s73 offen sc1
    s_add_u32 s73, s73, 16384
    buffer_load_dwordx4 v[144:147], v18, s[28:31], s72 offen sc1
    s_add_u32 s72, s72, 16384
    v_mfma_f32_32x32x16_bf16 v[80:95], a[4:7], v[212:215], v[80:95]
    s_waitcnt vmcnt(16)
    ds_read_b64_tr_b16 a[84:85], v17 offset:6144
    s_waitcnt lgkmcnt(14)
    v_mfma_f32_32x32x16_bf16 v[112:127], a[8:11], v[212:215], v[112:127]
    ds_read_b64_tr_b16 a[86:87], v17 offset:6912
    v_mfma_f32_32x32x16_bf16 v[32:47], a[180:183], v[188:191], v[32:47]
    ds_read_b64_tr_b16 a[88:89], v17 offset:6208
    ds_read_b64_tr_b16 a[90:91], v17 offset:6976
    v_mfma_f32_32x32x16_bf16 v[64:79], a[184:187], v[188:191], v[64:79]
    ds_read_b64_tr_b16 a[92:93], v17 offset:6272
    v_mfma_f32_32x32x16_bf16 v[96:111], a[188:191], v[188:191], v[96:111]
    ds_read_b64_tr_b16 a[94:95], v17 offset:7040
    s_waitcnt vmcnt(15)
    v_mfma_f32_32x32x16_bf16 v[48:63], a[12:15], v[216:219], v[48:63]
    buffer_load_dwordx4 v[236:239], v19, s[28:31], s73 offen sc1
    s_add_u32 s64, s71, 6
    s_and_b32 s64, s64, 7
    s_or_b32 s64, s64, 8
    s_lshl_b32 s73, s64, 15
    v_mfma_f32_32x32x16_bf16 v[80:95], a[16:19], v[216:219], v[80:95]
    buffer_load_dwordx4 v[148:151], v18, s[28:31], s72 offen sc1
    s_add_u32 s64, s71, 3
    s_and_b32 s64, s64, 7
    s_or_b32 s64, s64, 8
    s_lshl_b32 s72, s64, 15
    v_mfma_f32_32x32x16_bf16 v[112:127], a[20:23], v[216:219], v[112:127]
    s_add_u32 m0, s70, 15360
    s_nop 0
    buffer_load_dwordx4 v14, s[36:39], s69 offen offset:0  lds
    s_waitcnt vmcnt(17)
    v_mfma_f32_32x32x16_bf16 v[32:47], a[192:195], v[128:131], v[32:47]
    buffer_load_dwordx4 v15, s[36:39], s69 offen offset:1024  lds
    v_mfma_f32_32x32x16_bf16 v[64:79], a[196:199], v[128:131], v[64:79]
    buffer_load_dwordx4 v16, s[36:39], s69 offen offset:2048  lds
    v_mfma_f32_32x32x16_bf16 v[96:111], a[200:203], v[128:131], v[96:111]
    s_waitcnt vmcnt(18)
    v_mfma_f32_32x32x16_bf16 v[48:63], a[24:27], v[220:223], v[48:63]
    buffer_load_dwordx4 v[240:243], v19, s[28:31], s73 offen sc1
    s_add_u32 s73, s73, 16384
    buffer_load_dwordx4 v[152:155], v18, s[28:31], s72 offen sc1
    s_add_u32 s72, s72, 16384
    v_mfma_f32_32x32x16_bf16 v[80:95], a[28:31], v[220:223], v[80:95]
    s_waitcnt vmcnt(16)
    ds_read_b64_tr_b16 a[96:97], v17 offset:9216
    v_mfma_f32_32x32x16_bf16 v[112:127], a[32:35], v[220:223], v[112:127]
    ds_read_b64_tr_b16 a[98:99], v17 offset:9984
    v_mfma_f32_32x32x16_bf16 v[32:47], a[204:207], v[132:135], v[32:47]
    ds_read_b64_tr_b16 a[100:101], v17 offset:9280
    ds_read_b64_tr_b16 a[102:103], v17 offset:10048
    v_mfma_f32_32x32x16_bf16 v[64:79], a[208:211], v[132:135], v[64:79]
    ds_read_b64_tr_b16 a[104:105], v17 offset:9344
    v_mfma_f32_32x32x16_bf16 v[96:111], a[212:215], v[132:135], v[96:111]
    ds_read_b64_tr_b16 a[106:107], v17 offset:10112
    s_waitcnt vmcnt(15)
    v_mfma_f32_32x32x16_bf16 v[48:63], a[36:39], v[224:227], v[48:63]
    buffer_load_dwordx4 v[244:247], v19, s[28:31], s73 offen sc1
    s_add_u32 s64, s71, 7
    s_and_b32 s64, s64, 7
    s_or_b32 s64, s64, 8
    s_lshl_b32 s73, s64, 15
    v_mfma_f32_32x32x16_bf16 v[80:95], a[40:43], v[224:227], v[80:95]
    v_mfma_f32_32x32x16_bf16 v[112:127], a[44:47], v[224:227], v[112:127]
    s_waitcnt vmcnt(15)
    v_mfma_f32_32x32x16_bf16 v[32:47], a[216:219], v[136:139], v[32:47]
    buffer_load_dwordx4 v[156:159], v18, s[28:31], s72 offen sc1
    s_add_u32 s64, s71, 4
    s_and_b32 s64, s64, 7
    s_or_b32 s64, s64, 8
    s_lshl_b32 s72, s64, 15
    v_mfma_f32_32x32x16_bf16 v[64:79], a[220:223], v[136:139], v[64:79]
    v_mfma_f32_32x32x16_bf16 v[96:111], a[224:227], v[136:139], v[96:111]
    s_waitcnt vmcnt(15)
    v_mfma_f32_32x32x16_bf16 v[48:63], a[48:51], v[228:231], v[48:63]
    buffer_load_dwordx4 v[248:251], v19, s[28:31], s73 offen sc1
    s_add_u32 s73, s73, 16384
    buffer_load_dwordx4 v[160:163], v18, s[28:31], s72 offen sc1
    s_add_u32 s72, s72, 16384
    v_mfma_f32_32x32x16_bf16 v[80:95], a[52:55], v[228:231], v[80:95]
    s_waitcnt vmcnt(13)
    ds_read_b64_tr_b16 a[108:109], v17 offset:12288
    s_waitcnt lgkmcnt(14)
    v_mfma_f32_32x32x16_bf16 v[112:127], a[56:59], v[228:231], v[112:127]
    ds_read_b64_tr_b16 a[110:111], v17 offset:13056
    v_mfma_f32_32x32x16_bf16 v[32:47], a[228:231], v[140:143], v[32:47]
    ds_read_b64_tr_b16 a[112:113], v17 offset:12352
    ds_read_b64_tr_b16 a[114:115], v17 offset:13120
    v_mfma_f32_32x32x16_bf16 v[64:79], a[232:235], v[140:143], v[64:79]
    ds_read_b64_tr_b16 a[116:117], v17 offset:12416
    v_mfma_f32_32x32x16_bf16 v[96:111], a[236:239], v[140:143], v[96:111]
    ds_read_b64_tr_b16 a[118:119], v17 offset:13184
    s_waitcnt vmcnt(12)
    v_mfma_f32_32x32x16_bf16 v[48:63], a[60:63], v[232:235], v[48:63]
    buffer_load_dwordx4 v[252:255], v19, s[28:31], s73 offen sc1
    v_mfma_f32_32x32x16_bf16 v[80:95], a[64:67], v[232:235], v[80:95]
    v_mfma_f32_32x32x16_bf16 v[112:127], a[68:71], v[232:235], v[112:127]
    buffer_load_dwordx4 v[164:167], v18, s[28:31], s72 offen sc1
    s_add_u32 s64, s71, 5
    s_and_b32 s64, s64, 7
    s_or_b32 s64, s64, 8
    s_lshl_b32 s72, s64, 15
    s_waitcnt vmcnt(13)
    v_mfma_f32_32x32x16_bf16 v[32:47], a[240:243], v[144:147], v[32:47]
    v_mfma_f32_32x32x16_bf16 v[64:79], a[244:247], v[144:147], v[64:79]
    s_add_u32 m0, s67, 20480
    s_cmp_ge_u32 s10, 11
    s_cselect_b32 s11, -11, 0
    s_lshl_b32 s11, s11, 17
    s_add_u32 s11, s11, s65
    buffer_load_dwordx4 v2, s[40:43], s11 offen offset:0 lds
    v_mfma_f32_32x32x16_bf16 v[96:111], a[248:251], v[144:147], v[96:111]
    s_waitcnt vmcnt(13)
    v_mfma_f32_32x32x16_bf16 v[48:63], a[72:75], v[236:239], v[48:63]
    buffer_load_dwordx4 v[168:171], v18, s[28:31], s72 offen sc1
    s_add_u32 s72, s72, 16384
    buffer_load_dwordx4 v3, s[40:43], s11 offen offset:1024 lds
    v_mfma_f32_32x32x16_bf16 v[80:95], a[76:79], v[236:239], v[80:95]
    s_waitcnt vmcnt(11)
    ds_read_b64_tr_b16 a[120:121], v17 offset:15360
    s_waitcnt lgkmcnt(14)
    v_mfma_f32_32x32x16_bf16 v[112:127], a[80:83], v[236:239], v[112:127]
    ds_read_b64_tr_b16 a[122:123], v17 offset:16128
    v_mfma_f32_32x32x16_bf16 v[32:47], a[0:3], v[148:151], v[32:47]
    ds_read_b64_tr_b16 a[124:125], v17 offset:15424
    ds_read_b64_tr_b16 a[126:127], v17 offset:16192
    v_mfma_f32_32x32x16_bf16 v[64:79], a[4:7], v[148:151], v[64:79]
    ds_read_b64_tr_b16 a[128:129], v17 offset:15488
    v_mfma_f32_32x32x16_bf16 v[96:111], a[8:11], v[148:151], v[96:111]
    ds_read_b64_tr_b16 a[130:131], v17 offset:16256
    s_waitcnt vmcnt(10)
    v_mfma_f32_32x32x16_bf16 v[48:63], a[84:87], v[240:243], v[48:63]
    buffer_load_dwordx4 v[172:175], v18, s[28:31], s72 offen sc1
    s_add_u32 s64, s71, 6
    s_and_b32 s64, s64, 7
    s_or_b32 s64, s64, 8
    s_lshl_b32 s72, s64, 15
    v_mfma_f32_32x32x16_bf16 v[80:95], a[88:91], v[240:243], v[80:95]
    s_waitcnt lgkmcnt(14)
    v_mfma_f32_32x32x16_bf16 v[112:127], a[92:95], v[240:243], v[112:127]
    s_waitcnt vmcnt(10)
    v_mfma_f32_32x32x16_bf16 v[32:47], a[12:15], v[152:155], v[32:47]
    buffer_load_dwordx4 v4, s[40:43], s11 offen offset:2048 lds
    v_mfma_f32_32x32x16_bf16 v[64:79], a[16:19], v[152:155], v[64:79]
    v_mfma_f32_32x32x16_bf16 v[96:111], a[20:23], v[152:155], v[96:111]
    s_waitcnt vmcnt(10)
    v_mfma_f32_32x32x16_bf16 v[48:63], a[96:99], v[244:247], v[48:63]
    buffer_load_dwordx4 v[176:179], v18, s[28:31], s72 offen sc1
    s_add_u32 s72, s72, 16384
    v_mfma_f32_32x32x16_bf16 v[80:95], a[100:103], v[244:247], v[80:95]
    s_waitcnt lgkmcnt(12)
    v_mfma_f32_32x32x16_bf16 v[112:127], a[104:107], v[244:247], v[112:127]
    s_waitcnt vmcnt(10)
    v_mfma_f32_32x32x16_bf16 v[32:47], a[24:27], v[156:159], v[32:47]
    buffer_load_dwordx4 v5, s[40:43], s11 offen offset:3072 lds
    v_mfma_f32_32x32x16_bf16 v[64:79], a[28:31], v[156:159], v[64:79]
    v_mfma_f32_32x32x16_bf16 v[96:111], a[32:35], v[156:159], v[96:111]
    s_waitcnt vmcnt(10) lgkmcnt(10)
    v_mfma_f32_32x32x16_bf16 v[48:63], a[108:111], v[248:251], v[48:63]
    buffer_load_dwordx4 v[180:183], v18, s[28:31], s72 offen sc1
    s_add_u32 s64, s71, 7
    s_and_b32 s64, s64, 7
    s_or_b32 s64, s64, 8
    s_lshl_b32 s72, s64, 15
    s_waitcnt lgkmcnt(8)
    v_mfma_f32_32x32x16_bf16 v[80:95], a[112:115], v[248:251], v[80:95]
    s_waitcnt lgkmcnt(6)
    v_mfma_f32_32x32x16_bf16 v[112:127], a[116:119], v[248:251], v[112:127]
    s_waitcnt vmcnt(10)
    v_mfma_f32_32x32x16_bf16 v[32:47], a[36:39], v[160:163], v[32:47]
    s_add_u32 m0, s67, 24576
    s_cmp_ge_u32 s10, 10
    s_cselect_b32 s11, -10, 1
    s_lshl_b32 s11, s11, 17
    s_add_u32 s11, s11, s65
    buffer_load_dwordx4 v2, s[40:43], s11 offen offset:0 lds
    v_mfma_f32_32x32x16_bf16 v[64:79], a[40:43], v[160:163], v[64:79]
    v_mfma_f32_32x32x16_bf16 v[96:111], a[44:47], v[160:163], v[96:111]
    s_waitcnt vmcnt(10) lgkmcnt(4)
    v_mfma_f32_32x32x16_bf16 v[48:63], a[120:123], v[252:255], v[48:63]
    buffer_load_dwordx4 v[184:187], v18, s[28:31], s72 offen sc1
    s_add_u32 s72, s72, 16384
    s_waitcnt lgkmcnt(2)
    v_mfma_f32_32x32x16_bf16 v[80:95], a[124:127], v[252:255], v[80:95]
    s_waitcnt lgkmcnt(0)
    v_mfma_f32_32x32x16_bf16 v[112:127], a[128:131], v[252:255], v[112:127]
    s_waitcnt vmcnt(10)
    v_mfma_f32_32x32x16_bf16 v[32:47], a[48:51], v[164:167], v[32:47]
    buffer_load_dwordx4 v3, s[40:43], s11 offen offset:1024 lds
    v_mfma_f32_32x32x16_bf16 v[64:79], a[52:55], v[164:167], v[64:79]
    v_mfma_f32_32x32x16_bf16 v[96:111], a[56:59], v[164:167], v[96:111]
    s_waitcnt vmcnt(9)
    v_mfma_f32_32x32x16_bf16 v[32:47], a[60:63], v[168:171], v[32:47]
    buffer_load_dwordx4 v[188:191], v18, s[28:31], s72 offen sc1
    v_mfma_f32_32x32x16_bf16 v[64:79], a[64:67], v[168:171], v[64:79]
    buffer_load_dwordx4 v4, s[40:43], s11 offen offset:2048 lds
    v_mfma_f32_32x32x16_bf16 v[96:111], a[68:71], v[168:171], v[96:111]
    s_waitcnt vmcnt(9)
    v_mfma_f32_32x32x16_bf16 v[32:47], a[72:75], v[172:175], v[32:47]
    buffer_load_dwordx4 v5, s[40:43], s11 offen offset:3072 lds
    ds_write_b128 v20, v[48:51] offset:0
    v_mfma_f32_32x32x16_bf16 v[64:79], a[76:79], v[172:175], v[64:79]
    ds_write_b128 v20, v[52:55] offset:1024
    v_mfma_f32_32x32x16_bf16 v[96:111], a[80:83], v[172:175], v[96:111]
    ds_write_b128 v20, v[80:83] offset:2048
    s_waitcnt vmcnt(8)
    v_mfma_f32_32x32x16_bf16 v[32:47], a[84:87], v[176:179], v[32:47]
    s_add_u32 m0, s67, 28672
    s_cmp_ge_u32 s10, 9
    s_cselect_b32 s11, -9, 2
    s_lshl_b32 s11, s11, 17
    s_add_u32 s11, s11, s65
    buffer_load_dwordx4 v2, s[40:43], s11 offen offset:0 lds
    ds_write_b128 v20, v[84:87] offset:3072
    v_mfma_f32_32x32x16_bf16 v[64:79], a[88:91], v[176:179], v[64:79]
    ds_write_b128 v20, v[112:115] offset:4096
    v_mfma_f32_32x32x16_bf16 v[96:111], a[92:95], v[176:179], v[96:111]
    ds_write_b128 v20, v[116:119] offset:5120
    s_waitcnt vmcnt(7)
    v_mfma_f32_32x32x16_bf16 v[32:47], a[96:99], v[180:183], v[32:47]
    buffer_load_dwordx4 v3, s[40:43], s11 offen offset:1024 lds
    v_mfma_f32_32x32x16_bf16 v[64:79], a[100:103], v[180:183], v[64:79]
    ds_write_b128 v20, v[56:59] offset:12288
    v_mfma_f32_32x32x16_bf16 v[96:111], a[104:107], v[180:183], v[96:111]
    ds_write_b128 v20, v[60:63] offset:13312
    s_waitcnt vmcnt(6)
    v_mfma_f32_32x32x16_bf16 v[32:47], a[108:111], v[184:187], v[32:47]
    buffer_load_dwordx4 v4, s[40:43], s11 offen offset:2048 lds
    v_mfma_f32_32x32x16_bf16 v[64:79], a[112:115], v[184:187], v[64:79]
    ds_write_b128 v20, v[88:91] offset:14336
    v_mfma_f32_32x32x16_bf16 v[96:111], a[116:119], v[184:187], v[96:111]
    ds_write_b128 v20, v[92:95] offset:15360
    s_waitcnt vmcnt(5)
    v_mfma_f32_32x32x16_bf16 v[32:47], a[120:123], v[188:191], v[32:47]
    buffer_load_dwordx4 v5, s[40:43], s11 offen offset:3072 lds
    v_mfma_f32_32x32x16_bf16 v[64:79], a[124:127], v[188:191], v[64:79]
    ds_write_b128 v20, v[120:123] offset:16384
    v_mfma_f32_32x32x16_bf16 v[96:111], a[128:131], v[188:191], v[96:111]
    ds_write_b128 v20, v[124:127] offset:17408
    s_nop 6
    ds_write_b128 v20, v[40:43] offset:6144
    ds_write_b128 v20, v[44:47] offset:7168
    ds_write_b128 v20, v[72:75] offset:8192
    ds_write_b128 v20, v[76:79] offset:9216
    ds_write_b128 v20, v[104:107] offset:10240
    ds_write_b128 v20, v[108:111] offset:11264
    s_waitcnt lgkmcnt(0)
    s_barrier
    ds_read_b128 v[128:131], v21 offset:0
    ds_read_b128 v[132:135], v21 offset:1024
    ds_read_b128 v[136:139], v22 offset:6144
    ds_read_b128 v[140:143], v22 offset:7168
    ds_read_b128 v[144:147], v23 offset:12288
    ds_read_b128 v[148:151], v23 offset:13312
    ds_read_b128 v[152:155], v21 offset:2048
    ds_read_b128 v[156:159], v21 offset:3072
    ds_read_b128 v[160:163], v22 offset:8192
    ds_read_b128 v[164:167], v22 offset:9216
    ds_read_b128 v[168:171], v23 offset:14336
    ds_read_b128 v[172:175], v23 offset:15360
    ds_read_b128 v[176:179], v21 offset:4096
    ds_read_b128 v[180:183], v21 offset:5120
    ds_read_b128 v[184:187], v22 offset:10240
    ds_read_b128 v[188:191], v22 offset:11264
    ds_read_b128 v[192:195], v23 offset:16384
    ds_read_b128 v[196:199], v23 offset:17408
    s_waitcnt lgkmcnt(14)
    v_pk_add_f32 v[32:33], v[32:33], v[128:129]
    s_add_u32 m0, s67, 32768
    s_cmp_ge_u32 s10, 8
    s_cselect_b32 s11, -8, 3
    s_lshl_b32 s11, s11, 17
    s_add_u32 s11, s11, s65
    buffer_load_dwordx4 v2, s[40:43], s11 offen offset:0 lds
    v_pk_add_f32 v[34:35], v[34:35], v[130:131]
    v_pk_add_f32 v[36:37], v[36:37], v[132:133]
    v_pk_add_f32 v[38:39], v[38:39], v[134:135]
    v_pk_add_f32 v[32:33], v[32:33], v[136:137]
    v_pk_add_f32 v[34:35], v[34:35], v[138:139]
    v_pk_add_f32 v[36:37], v[36:37], v[140:141]
    v_pk_add_f32 v[38:39], v[38:39], v[142:143]
    s_waitcnt lgkmcnt(13)
    v_pk_add_f32 v[32:33], v[32:33], v[144:145]
    v_pk_add_f32 v[34:35], v[34:35], v[146:147]
    s_waitcnt lgkmcnt(12)
    v_pk_add_f32 v[36:37], v[36:37], v[148:149]
    v_pk_add_f32 v[38:39], v[38:39], v[150:151]
    v_pk_mul_f32 v[128:129], v[32:33], v[32:33]
    v_pk_mul_f32 v[130:131], v[34:35], v[34:35]
    v_pk_mul_f32 v[132:133], v[36:37], v[36:37]
    buffer_load_dwordx4 v3, s[40:43], s11 offen offset:1024 lds
    v_pk_mul_f32 v[134:135], v[38:39], v[38:39]
    v_pk_fma_f32 v[128:129], v[128:129], s[60:61], v[24:25] op_sel_hi:[1,0,0]
    v_pk_fma_f32 v[130:131], v[130:131], s[60:61], v[24:25] op_sel_hi:[1,0,0]
    v_pk_fma_f32 v[132:133], v[132:133], s[60:61], v[24:25] op_sel_hi:[1,0,0]
    v_pk_fma_f32 v[134:135], v[134:135], s[60:61], v[24:25] op_sel_hi:[1,0,0]
    v_pk_mul_f32 v[128:129], v[128:129], v[32:33]
    v_pk_mul_f32 v[130:131], v[130:131], v[34:35]
    v_pk_mul_f32 v[132:133], v[132:133], v[36:37]
    v_pk_mul_f32 v[134:135], v[134:135], v[38:39]
    v_exp_f32 v128, v128
    v_exp_f32 v129, v129
    v_exp_f32 v130, v130
    v_exp_f32 v131, v131
    v_exp_f32 v132, v132
    v_exp_f32 v133, v133
    buffer_load_dwordx4 v4, s[40:43], s11 offen offset:2048 lds
    v_exp_f32 v134, v134
    v_exp_f32 v135, v135
    v_pk_add_f32 v[128:129], v[128:129], 1.0 op_sel_hi:[1,0]
    v_pk_add_f32 v[130:131], v[130:131], 1.0 op_sel_hi:[1,0]
    v_pk_add_f32 v[132:133], v[132:133], 1.0 op_sel_hi:[1,0]
    v_pk_add_f32 v[134:135], v[134:135], 1.0 op_sel_hi:[1,0]
    v_rcp_f32 v128, v128
    v_rcp_f32 v129, v129
    v_rcp_f32 v130, v130
    v_rcp_f32 v131, v131
    v_rcp_f32 v132, v132
    v_rcp_f32 v133, v133
    v_rcp_f32 v134, v134
    v_rcp_f32 v135, v135
    v_pk_mul_f32 v[32:33], v[32:33], v[128:129]
    buffer_load_dwordx4 v5, s[40:43], s11 offen offset:3072 lds
    v_pk_mul_f32 v[34:35], v[34:35], v[130:131]
    v_pk_mul_f32 v[36:37], v[36:37], v[132:133]
    v_pk_mul_f32 v[38:39], v[38:39], v[134:135]
    v_cvt_pk_bf16_f32 v136, v32, v33
    v_cvt_pk_bf16_f32 v137, v34, v35
    v_cvt_pk_bf16_f32 v138, v36, v37
    v_cvt_pk_bf16_f32 v139, v38, v39
    buffer_store_dwordx4 v[136:139], v27, s[28:31], s74 offen sc1
    s_waitcnt lgkmcnt(11)
    v_pk_add_f32 v[64:65], v[64:65], v[152:153]
    v_pk_add_f32 v[66:67], v[66:67], v[154:155]
    s_waitcnt lgkmcnt(10)
    v_pk_add_f32 v[68:69], v[68:69], v[156:157]
    v_pk_add_f32 v[70:71], v[70:71], v[158:159]
    s_waitcnt lgkmcnt(9)
    v_pk_add_f32 v[64:65], v[64:65], v[160:161]
    v_pk_add_f32 v[66:67], v[66:67], v[162:163]
    s_waitcnt lgkmcnt(8)
    v_pk_add_f32 v[68:69], v[68:69], v[164:165]
    s_add_u32 m0, s67, 36864
    s_cmp_ge_u32 s10, 7
    s_cselect_b32 s11, -7, 4
    s_lshl_b32 s11, s11, 17
    s_add_u32 s11, s11, s65
    buffer_load_dwordx4 v2, s[40:43], s11 offen offset:0 lds
    v_pk_add_f32 v[70:71], v[70:71], v[166:167]
    s_waitcnt lgkmcnt(7)
    v_pk_add_f32 v[64:65], v[64:65], v[168:169]
    v_pk_add_f32 v[66:67], v[66:67], v[170:171]
    s_waitcnt lgkmcnt(6)
    v_pk_add_f32 v[68:69], v[68:69], v[172:173]
    v_pk_add_f32 v[70:71], v[70:71], v[174:175]
    v_pk_mul_f32 v[152:153], v[64:65], v[64:65]
    v_pk_mul_f32 v[154:155], v[66:67], v[66:67]
    v_pk_mul_f32 v[156:157], v[68:69], v[68:69]
    v_pk_mul_f32 v[158:159], v[70:71], v[70:71]
    v_pk_fma_f32 v[152:153], v[152:153], s[60:61], v[24:25] op_sel_hi:[1,0,0]
    v_pk_fma_f32 v[154:155], v[154:155], s[60:61], v[24:25] op_sel_hi:[1,0,0]
    v_pk_fma_f32 v[156:157], v[156:157], s[60:61], v[24:25] op_sel_hi:[1,0,0]
    v_pk_fma_f32 v[158:159], v[158:159], s[60:61], v[24:25] op_sel_hi:[1,0,0]
    v_pk_mul_f32 v[152:153], v[152:153], v[64:65]
    buffer_load_dwordx4 v3, s[40:43], s11 offen offset:1024 lds
    v_pk_mul_f32 v[154:155], v[154:155], v[66:67]
    v_pk_mul_f32 v[156:157], v[156:157], v[68:69]
    v_pk_mul_f32 v[158:159], v[158:159], v[70:71]
    v_exp_f32 v152, v152
    v_exp_f32 v153, v153
    v_exp_f32 v154, v154
    v_exp_f32 v155, v155
    v_exp_f32 v156, v156
    v_exp_f32 v157, v157
    v_exp_f32 v158, v158
    v_exp_f32 v159, v159
    v_pk_add_f32 v[152:153], v[152:153], 1.0 op_sel_hi:[1,0]
    v_pk_add_f32 v[154:155], v[154:155], 1.0 op_sel_hi:[1,0]
    v_pk_add_f32 v[156:157], v[156:157], 1.0 op_sel_hi:[1,0]
    v_pk_add_f32 v[158:159], v[158:159], 1.0 op_sel_hi:[1,0]
    buffer_load_dwordx4 v4, s[40:43], s11 offen offset:2048 lds
    v_rcp_f32 v152, v152
    v_rcp_f32 v153, v153
    v_rcp_f32 v154, v154
    v_rcp_f32 v155, v155
    v_rcp_f32 v156, v156
    v_rcp_f32 v157, v157
    v_rcp_f32 v158, v158
    v_rcp_f32 v159, v159
    v_pk_mul_f32 v[64:65], v[64:65], v[152:153]
    v_pk_mul_f32 v[66:67], v[66:67], v[154:155]
    v_pk_mul_f32 v[68:69], v[68:69], v[156:157]
    v_pk_mul_f32 v[70:71], v[70:71], v[158:159]
    v_cvt_pk_bf16_f32 v160, v64, v65
    v_cvt_pk_bf16_f32 v161, v66, v67
    v_cvt_pk_bf16_f32 v162, v68, v69
    buffer_load_dwordx4 v5, s[40:43], s11 offen offset:3072 lds
    v_cvt_pk_bf16_f32 v163, v70, v71
    buffer_store_dwordx4 v[160:163], v27, s[28:31], s75 offen sc1
    s_waitcnt lgkmcnt(5)
    v_pk_add_f32 v[96:97], v[96:97], v[176:177]
    v_pk_add_f32 v[98:99], v[98:99], v[178:179]
    s_waitcnt lgkmcnt(4)
    v_pk_add_f32 v[100:101], v[100:101], v[180:181]
    v_pk_add_f32 v[102:103], v[102:103], v[182:183]
    s_waitcnt lgkmcnt(3)
    v_pk_add_f32 v[96:97], v[96:97], v[184:185]
    v_pk_add_f32 v[98:99], v[98:99], v[186:187]
    s_waitcnt lgkmcnt(2)
    v_pk_add_f32 v[100:101], v[100:101], v[188:189]
    v_pk_add_f32 v[102:103], v[102:103], v[190:191]
    s_waitcnt lgkmcnt(1)
    v_pk_add_f32 v[96:97], v[96:97], v[192:193]
    v_pk_add_f32 v[98:99], v[98:99], v[194:195]
    s_waitcnt lgkmcnt(0)
    v_pk_add_f32 v[100:101], v[100:101], v[196:197]
    v_pk_add_f32 v[102:103], v[102:103], v[198:199]
    s_barrier
    v_pk_mul_f32 v[176:177], v[96:97], v[96:97]
    v_pk_mul_f32 v[178:179], v[98:99], v[98:99]
    v_pk_mul_f32 v[180:181], v[100:101], v[100:101]
    v_pk_mul_f32 v[182:183], v[102:103], v[102:103]
    v_pk_fma_f32 v[176:177], v[176:177], s[60:61], v[24:25] op_sel_hi:[1,0,0]
    v_pk_fma_f32 v[178:179], v[178:179], s[60:61], v[24:25] op_sel_hi:[1,0,0]
    v_pk_fma_f32 v[180:181], v[180:181], s[60:61], v[24:25] op_sel_hi:[1,0,0]
    v_pk_fma_f32 v[182:183], v[182:183], s[60:61], v[24:25] op_sel_hi:[1,0,0]
    v_pk_mul_f32 v[176:177], v[176:177], v[96:97]
    v_pk_mul_f32 v[178:179], v[178:179], v[98:99]
    v_pk_mul_f32 v[180:181], v[180:181], v[100:101]
    v_pk_mul_f32 v[182:183], v[182:183], v[102:103]
    v_exp_f32 v176, v176
    v_exp_f32 v177, v177
    v_exp_f32 v178, v178
    v_exp_f32 v179, v179
    v_exp_f32 v180, v180
    v_exp_f32 v181, v181
    v_exp_f32 v182, v182
    v_exp_f32 v183, v183
    v_pk_add_f32 v[176:177], v[176:177], 1.0 op_sel_hi:[1,0]
    v_pk_add_f32 v[178:179], v[178:179], 1.0 op_sel_hi:[1,0]
    v_pk_add_f32 v[180:181], v[180:181], 1.0 op_sel_hi:[1,0]
    v_pk_add_f32 v[182:183], v[182:183], 1.0 op_sel_hi:[1,0]
    v_rcp_f32 v176, v176
    v_rcp_f32 v177, v177
    v_rcp_f32 v178, v178
    v_rcp_f32 v179, v179
    v_rcp_f32 v180, v180
    v_rcp_f32 v181, v181
    v_rcp_f32 v182, v182
    v_rcp_f32 v183, v183
    v_pk_mul_f32 v[96:97], v[96:97], v[176:177]
    v_pk_mul_f32 v[98:99], v[98:99], v[178:179]
    v_pk_mul_f32 v[100:101], v[100:101], v[180:181]
    v_pk_mul_f32 v[102:103], v[102:103], v[182:183]
    v_cvt_pk_bf16_f32 v184, v96, v97
    v_cvt_pk_bf16_f32 v185, v98, v99
    v_cvt_pk_bf16_f32 v186, v100, v101
    v_cvt_pk_bf16_f32 v187, v102, v103
    buffer_store_dwordx4 v[184:187], v27, s[28:31], s76 offen sc1
    ds_read_b64_tr_b16 a[0:1], v10 offset:20480
    ds_read_b64_tr_b16 a[2:3], v10 offset:21504
    ds_read_b64_tr_b16 a[4:5], v11 offset:20480
    ds_read_b64_tr_b16 a[6:7], v11 offset:21504
    ds_read_b64_tr_b16 a[8:9], v10 offset:22528
    ds_read_b64_tr_b16 a[10:11], v10 offset:23552
    ds_read_b64_tr_b16 a[12:13], v11 offset:22528
    ds_read_b64_tr_b16 a[14:15], v11 offset:23552
    s_waitcnt vmcnt(15)
    ds_read_b64_tr_b16 a[16:17], v10 offset:24576
    ds_read_b64_tr_b16 a[18:19], v10 offset:25600
    ds_read_b64_tr_b16 a[20:21], v11 offset:24576
    ds_read_b64_tr_b16 a[22:23], v11 offset:25600
    ds_read_b64_tr_b16 a[24:25], v10 offset:26624
    ds_read_b64_tr_b16 a[26:27], v10 offset:27648
    ds_read_b64_tr_b16 a[28:29], v11 offset:26624
    ds_read_b64_tr_b16 a[30:31], v11 offset:27648
    s_lshl4_add_u32 s59, s57, s58
    s_lshl2_add_u32 s59, s59, s3
    s_lshl_b32 s62, s59, 7
    s_add_u32 s62, s62, 0x50000
    s_waitcnt vmcnt(0)
    s_mov_b64 exec, 1
    buffer_store_dwordx2 v[28:29], off, s[28:31], s62 sc1
    s_mov_b64 exec, -1
    s_add_u32 m0, s67, 0
    s_cmp_ge_u32 s10, 6
    s_cselect_b32 s11, -6, 5
    s_lshl_b32 s11, s11, 17
    s_add_u32 s11, s11, s65
    buffer_load_dwordx4 v2, s[40:43], s11 offen offset:0 lds
    buffer_load_dwordx4 v3, s[40:43], s11 offen offset:1024 lds
    buffer_load_dwordx4 v4, s[40:43], s11 offen offset:2048 lds
    buffer_load_dwordx4 v5, s[40:43], s11 offen offset:3072 lds
    s_add_u32 m0, s67, 4096
    s_cmp_ge_u32 s10, 5
    s_cselect_b32 s11, -5, 6
    s_lshl_b32 s11, s11, 17
    s_add_u32 s11, s11, s65
    buffer_load_dwordx4 v2, s[40:43], s11 offen offset:0 lds
    buffer_load_dwordx4 v3, s[40:43], s11 offen offset:1024 lds
    buffer_load_dwordx4 v4, s[40:43], s11 offen offset:2048 lds
    buffer_load_dwordx4 v5, s[40:43], s11 offen offset:3072 lds
    s_add_u32 m0, s67, 8192
    s_cmp_ge_u32 s10, 4
    s_cselect_b32 s11, -4, 7
    s_lshl_b32 s11, s11, 17
    s_add_u32 s11, s11, s65
    buffer_load_dwordx4 v2, s[40:43], s11 offen offset:0 lds
    buffer_load_dwordx4 v3, s[40:43], s11 offen offset:1024 lds
    buffer_load_dwordx4 v4, s[40:43], s11 offen offset:2048 lds
    buffer_load_dwordx4 v5, s[40:43], s11 offen offset:3072 lds
    s_add_u32 m0, s67, 12288
    s_cmp_ge_u32 s10, 3
    s_cselect_b32 s11, -3, 8
    s_lshl_b32 s11, s11, 17
    s_add_u32 s11, s11, s65
    buffer_load_dwordx4 v2, s[40:43], s11 offen offset:0 lds
    buffer_load_dwordx4 v3, s[40:43], s11 offen offset:1024 lds
    buffer_load_dwordx4 v4, s[40:43], s11 offen offset:2048 lds
    buffer_load_dwordx4 v5, s[40:43], s11 offen offset:3072 lds
    s_add_u32 m0, s67, 16384
    s_cmp_ge_u32 s10, 2
    s_cselect_b32 s11, -2, 9
    s_lshl_b32 s11, s11, 17
    s_add_u32 s11, s11, s65
    buffer_load_dwordx4 v2, s[40:43], s11 offen offset:0 lds
    buffer_load_dwordx4 v3, s[40:43], s11 offen offset:1024 lds
    buffer_load_dwordx4 v4, s[40:43], s11 offen offset:2048 lds
    buffer_load_dwordx4 v5, s[40:43], s11 offen offset:3072 lds
    s_waitcnt lgkmcnt(8)
    s_add_u32 m0, s67, 20480
    s_cmp_ge_u32 s10, 1
    s_cselect_b32 s11, -1, 10
    s_lshl_b32 s11, s11, 17
    s_add_u32 s11, s11, s65
    buffer_load_dwordx4 v2, s[40:43], s11 offen offset:0 lds
    buffer_load_dwordx4 v3, s[40:43], s11 offen offset:1024 lds
    buffer_load_dwordx4 v4, s[40:43], s11 offen offset:2048 lds
    buffer_load_dwordx4 v5, s[40:43], s11 offen offset:3072 lds
    ds_read_b64_tr_b16 a[32:33], v10 offset:28672
    ds_read_b64_tr_b16 a[34:35], v10 offset:29696
    ds_read_b64_tr_b16 a[36:37], v11 offset:28672
    ds_read_b64_tr_b16 a[38:39], v11 offset:29696
    ds_read_b64_tr_b16 a[40:41], v10 offset:30720
    ds_read_b64_tr_b16 a[42:43], v10 offset:31744
    ds_read_b64_tr_b16 a[44:45], v11 offset:30720
    ds_read_b64_tr_b16 a[46:47], v11 offset:31744
    ds_read_b64_tr_b16 a[48:49], v10 offset:32768
    ds_read_b64_tr_b16 a[50:51], v10 offset:33792
    ds_read_b64_tr_b16 a[52:53], v11 offset:32768
    ds_read_b64_tr_b16 a[54:55], v11 offset:33792
    ds_read_b64_tr_b16 a[56:57], v10 offset:34816
    ds_read_b64_tr_b16 a[58:59], v10 offset:35840
    ds_read_b64_tr_b16 a[60:61], v11 offset:34816
    ds_read_b64_tr_b16 a[62:63], v11 offset:35840
    ds_read_b64_tr_b16 a[64:65], v10 offset:36864
    ds_read_b64_tr_b16 a[66:67], v10 offset:37888
    ds_read_b64_tr_b16 a[68:69], v11 offset:36864
    ds_read_b64_tr_b16 a[70:71], v11 offset:37888
    ds_read_b64_tr_b16 a[72:73], v10 offset:38912
    ds_read_b64_tr_b16 a[74:75], v10 offset:39936
    ds_read_b64_tr_b16 a[76:77], v11 offset:38912
    ds_read_b64_tr_b16 a[78:79], v11 offset:39936
    s_mov_b64 s[48:49], s[18:19]
    s_mov_b32 s50, 0x1000
    s_mov_b32 s51, 0x20000
    v_lshrrev_b32 v24, 2, v0
    v_and_b32 v25, 3, v0
    v_lshlrev_b32 v22, 4, v25
    v_lshl_add_u32 v23, v24, 10, v22
    s_and_b32 s70, s55, 0
    s_lshl_b32 s70, s70, 6
    v_xor_b32 v23, s70, v23
    v_xor_b32 v233, 64, v23
    v_xor_b32 v12, s70, v12
    v_xor_b32 v13, s70, v13
    v_lshlrev_b32 v22, 1, v24
    s_lshl_b32 s69, s55, 16
    s_lshl_b32 s59, s56, 7
    s_add_u32 s69, s69, s59
    s_lshl_b32 s59, s55, 7
    buffer_load_dwordx4 v[248:251], v23, s[32:35], s69 offen
    buffer_load_dwordx4 v[252:255], v233, s[32:35], s69 offen
    buffer_load_ushort v232, v22, s[48:51], s59 offen
    v_xor_b32 v25, v24, v25
    v_and_b32 v25, 7, v25
    v_lshlrev_b32 v25, 4, v25
    v_and_b32 v24, 31, v24
    v_lshl_add_u32 v22, v24, 7, v25
    v_lshrrev_b32 v24, 5, v1
    v_and_b32 v25, 31, v1
    v_lshlrev_b32 v25, 7, v25
    v_lshl_add_u32 v24, v24, 12, v25
    v_and_b32 v25, 7, v1
    v_lshl_add_u32 v24, v25, 4, v24
    v_add_u32 v14, s67, v24
    v_xor_b32 v15, 16, v14
    v_xor_b32 v16, 32, v14
    v_xor_b32 v17, 48, v14
    v_xor_b32 v18, 64, v14
    v_xor_b32 v19, 80, v14
    v_xor_b32 v20, 96, v14
    v_xor_b32 v21, 112, v14
    s_lshl2_add_u32 s59, s56, s3
    s_lshl_b32 s59, s59, 11
    s_add_u32 s59, s59, 0x50000
    v_lshrrev_b32 v24, 2, v1
    v_lshlrev_b32 v24, 7, v24
    v_add_u32 v26, s59, v24
    s_mul_i32 s71, s3, 360448
    s_lshl_b32 s59, s56, 11
    s_add_u32 s71, s71, s59
    s_add_u32 s71, s71, 0x700400
    s_lshl_b32 s59, s70, 4
    s_xor_b32 s71, s71, s59
    s_add_u32 s75, s71, 360448
    s_mov_b32 s74, s71
    s_lshl_b32 s59, s10, 15
    s_add_u32 s71, s71, s59
    s_mov_b32 s72, s71
    s_lshr_b32 s62, s3, 1
    s_lshl1_add_u32 s59, s55, s62
    s_lshl_b32 s59, s59, 10
    s_add_u32 s59, s59, 0x60000
    v_lshrrev_b32 v24, 3, v1
    v_lshlrev_b32 v24, 7, v24
    v_add_u32 v25, s59, v24
    s_and_b32 s59, s3, 1
    s_lshl1_add_u32 s59, s55, s59
    s_lshl1_add_u32 s59, s59, s62
    s_lshl_b32 s73, s59, 14
    s_add_u32 s73, s73, 0x500000
    s_mov_b32 s60, 0xbfb8aa3b
    s_waitcnt lgkmcnt(0)
L_ys:
    buffer_load_dwordx2 v[30:31], v26, s[28:31], 0 offen sc1
    s_add_u32 m0, s67, 24576
    s_add_u32 s11, s66, 0
    buffer_load_dwordx4 v6, s[44:47], s11 offen offset:0 lds
    buffer_load_dwordx4 v7, s[44:47], s11 offen offset:1024 lds
    buffer_load_dwordx4 v8, s[44:47], s11 offen offset:2048 lds
    buffer_load_dwordx4 v9, s[44:47], s11 offen offset:3072 lds
    s_add_u32 m0, s67, 28672
    s_add_u32 s11, s66, 32768
    buffer_load_dwordx4 v6, s[44:47], s11 offen offset:0 lds
    buffer_load_dwordx4 v7, s[44:47], s11 offen offset:1024 lds
    buffer_load_dwordx4 v8, s[44:47], s11 offen offset:2048 lds
    buffer_load_dwordx4 v9, s[44:47], s11 offen offset:3072 lds
    s_add_u32 m0, s67, 32768
    s_add_u32 s11, s66, 65536
    buffer_load_dwordx4 v6, s[44:47], s11 offen offset:0 lds
    buffer_load_dwordx4 v7, s[44:47], s11 offen offset:1024 lds
    buffer_load_dwordx4 v8, s[44:47], s11 offen offset:2048 lds
    buffer_load_dwordx4 v9, s[44:47], s11 offen offset:3072 lds
    s_add_u32 m0, s67, 36864
    s_add_u32 s11, s66, 98304
    buffer_load_dwordx4 v6, s[44:47], s11 offen offset:0 lds
    buffer_load_dwordx4 v7, s[44:47], s11 offen offset:1024 lds
    buffer_load_dwordx4 v8, s[44:47], s11 offen offset:2048 lds
    buffer_load_dwordx4 v9, s[44:47], s11 offen offset:3072 lds
    s_waitcnt vmcnt(16)
    v_cmp_ne_u64 vcc, s[26:27], v[30:31]
    s_nop 0
    s_cbranch_vccz L_ok3
    s_mov_b32 s77, 0
L_spin3:
    s_sleep 1
    buffer_load_dwordx2 v[30:31], v26, s[28:31], 0 offen sc1
    s_add_u32 s77, s77, 1
    s_cmp_ge_u32 s77, 0x10000
    s_waitcnt vmcnt(0)
    s_cbranch_scc1 L_ok3
    v_cmp_ne_u64 vcc, s[26:27], v[30:31]
    s_nop 0
    s_cbranch_vccnz L_spin3
L_ok3:
    v_mov_b32 v26, v25
    v_add_u32 v3, 16384, v27
    buffer_load_dwordx4 v[160:163], v27, s[28:31], s71 offen sc1
    buffer_load_dwordx4 v[164:167], v3, s[28:31], s71 offen sc1
    s_add_u32 s71, s71, 32768
    buffer_load_dwordx4 v[168:171], v27, s[28:31], s71 offen sc1
    buffer_load_dwordx4 v[172:175], v3, s[28:31], s71 offen sc1
    s_add_u32 s71, s71, 32768
    s_cmp_eq_u32 s71, s75
    s_cselect_b32 s71, s74, s71
    buffer_load_dwordx4 v[176:179], v27, s[28:31], s71 offen sc1
    buffer_load_dwordx4 v[180:183], v3, s[28:31], s71 offen sc1
    s_add_u32 s71, s71, 32768
    buffer_load_dwordx4 v[184:187], v27, s[28:31], s71 offen sc1
    buffer_load_dwordx4 v[188:191], v3, s[28:31], s71 offen sc1
    s_add_u32 s71, s71, 32768
    buffer_load_dwordx4 v[192:195], v27, s[28:31], s71 offen sc1
    buffer_load_dwordx4 v[196:199], v3, s[28:31], s71 offen sc1
    s_add_u32 s71, s71, 32768
    s_cmp_eq_u32 s71, s75
    s_cselect_b32 s71, s74, s71
    buffer_load_dwordx4 v[200:203], v27, s[28:31], s71 offen sc1
    buffer_load_dwordx4 v[204:207], v3, s[28:31], s71 offen sc1
    s_add_u32 s71, s71, 32768
    v_lshlrev_b32 v2, 16, v232
    s_lshr_b32 s59, s3, 1
    s_lshl_b32 s62, s59, 13
    v_add_u32 v4, s62, v22
    v_add_u32 v5, 81920, v4
    v_xor_b32 v6, 64, v4
    v_xor_b32 v7, 64, v5
    s_mul_i32 s62, s59, 40960
    v_add_u32 v8, s62, v22
    v_add_u32 v9, 81920, v8
    v_xor_b32 v24, 64, v8
    v_xor_b32 v25, 64, v9
    v_xor_b32 v22, 64, v23
    s_mov_b64 s[32:33], s[20:21]
    s_mov_b32 s34, 0x200000
    s_mov_b32 s35, 0x20000
    ds_read_b64_tr_b16 a[80:81], v10 offset:0
    ds_read_b64_tr_b16 a[82:83], v10 offset:1024
    ds_read_b64_tr_b16 a[84:85], v11 offset:0
    ds_read_b64_tr_b16 a[86:87], v11 offset:1024
    ds_read_b64_tr_b16 a[88:89], v10 offset:2048
    ds_read_b64_tr_b16 a[90:91], v10 offset:3072
    ds_read_b64_tr_b16 a[92:93], v11 offset:2048
    ds_read_b64_tr_b16 a[94:95], v11 offset:3072
    ds_read_b64_tr_b16 a[96:97], v10 offset:4096
    ds_read_b64_tr_b16 a[98:99], v10 offset:5120
    ds_read_b64_tr_b16 a[100:101], v11 offset:4096
    ds_read_b64_tr_b16 a[102:103], v11 offset:5120
    ds_read_b64_tr_b16 a[104:105], v10 offset:6144
    ds_read_b64_tr_b16 a[106:107], v10 offset:7168
    ds_read_b64_tr_b16 a[108:109], v11 offset:6144
    ds_read_b64_tr_b16 a[110:111], v11 offset:7168
    ds_read_b64_tr_b16 a[112:113], v10 offset:8192
    ds_read_b64_tr_b16 a[114:115], v10 offset:9216
    ds_read_b64_tr_b16 a[116:117], v11 offset:8192
    ds_read_b64_tr_b16 a[118:119], v11 offset:9216
    ds_read_b64_tr_b16 a[120:121], v10 offset:10240
    ds_read_b64_tr_b16 a[122:123], v10 offset:11264
    ds_read_b64_tr_b16 a[124:125], v11 offset:10240
    ds_read_b64_tr_b16 a[126:127], v11 offset:11264
    s_waitcnt vmcnt(11)
    v_mfma_f32_32x32x16_bf16 v[64:79], v[160:163], a[0:3], 0
    buffer_load_dwordx4 v[208:211], v27, s[28:31], s71 offen sc1
    buffer_load_dwordx2 v[30:31], v26, s[28:31], 0 offen sc1
    ds_read_b64_tr_b16 a[128:129], v10 offset:12288
    ds_read_b64_tr_b16 a[130:131], v10 offset:13312
    ds_read_b64_tr_b16 a[132:133], v11 offset:12288
    v_mfma_f32_32x32x16_bf16 v[80:95], v[160:163], a[4:7], 0
    ds_read_b64_tr_b16 a[134:135], v11 offset:13312
    ds_read_b64_tr_b16 a[136:137], v10 offset:14336
    ds_read_b64_tr_b16 a[138:139], v10 offset:15360
    s_waitcnt vmcnt(12)
    v_mfma_f32_32x32x16_bf16 v[64:79], v[164:167], a[8:11], v[64:79]
    buffer_load_dwordx4 v[212:215], v3, s[28:31], s71 offen sc1
    s_add_u32 s71, s71, 32768
    ds_read_b64_tr_b16 a[140:141], v11 offset:14336
    ds_read_b64_tr_b16 a[142:143], v11 offset:15360
    ds_read_b64_tr_b16 a[144:145], v10 offset:16384
    v_mfma_f32_32x32x16_bf16 v[80:95], v[164:167], a[12:15], v[80:95]
    ds_read_b64_tr_b16 a[146:147], v10 offset:17408
    ds_read_b64_tr_b16 a[148:149], v11 offset:16384
    ds_read_b64_tr_b16 a[150:151], v11 offset:17408
    s_waitcnt vmcnt(12)
    v_mfma_f32_32x32x16_bf16 v[64:79], v[168:171], a[16:19], v[64:79]
    buffer_load_dwordx4 v[216:219], v27, s[28:31], s71 offen sc1
    ds_read_b64_tr_b16 a[152:153], v10 offset:18432
    ds_read_b64_tr_b16 a[154:155], v10 offset:19456
    ds_read_b64_tr_b16 a[156:157], v11 offset:18432
    v_mfma_f32_32x32x16_bf16 v[80:95], v[168:171], a[20:23], v[80:95]
    ds_read_b64_tr_b16 a[158:159], v11 offset:19456
    ds_read_b64_tr_b16 a[160:161], v10 offset:20480
    ds_read_b64_tr_b16 a[162:163], v10 offset:21504
    s_waitcnt vmcnt(12)
    v_mfma_f32_32x32x16_bf16 v[64:79], v[172:175], a[24:27], v[64:79]
    buffer_load_dwordx4 v[220:223], v3, s[28:31], s71 offen sc1
    s_add_u32 s71, s71, 32768
    s_cmp_eq_u32 s71, s75
    s_cselect_b32 s71, s74, s71
    ds_read_b64_tr_b16 a[164:165], v11 offset:20480
    ds_read_b64_tr_b16 a[166:167], v11 offset:21504
    ds_read_b64_tr_b16 a[168:169], v10 offset:22528
    v_mfma_f32_32x32x16_bf16 v[80:95], v[172:175], a[28:31], v[80:95]
    ds_read_b64_tr_b16 a[170:171], v10 offset:23552
    ds_read_b64_tr_b16 a[172:173], v11 offset:22528
    ds_read_b64_tr_b16 a[174:175], v11 offset:23552
    s_waitcnt vmcnt(12)
    v_mfma_f32_32x32x16_bf16 v[64:79], v[176:179], a[32:35], v[64:79]
    buffer_load_dwordx4 v[224:227], v27, s[28:31], s71 offen sc1
    v_mfma_f32_32x32x16_bf16 v[80:95], v[176:179], a[36:39], v[80:95]
    s_waitcnt vmcnt(12)
    v_mfma_f32_32x32x16_bf16 v[64:79], v[180:183], a[40:43], v[64:79]
    buffer_load_dwordx4 v[228:231], v3, s[28:31], s71 offen sc1
    s_add_u32 s71, s71, 32768
    v_mfma_f32_32x32x16_bf16 v[80:95], v[180:183], a[44:47], v[80:95]
    s_waitcnt vmcnt(12)
    v_mfma_f32_32x32x16_bf16 v[64:79], v[184:187], a[48:51], v[64:79]
    buffer_load_dwordx4 v[160:163], v27, s[28:31], s71 offen sc1
    v_mfma_f32_32x32x16_bf16 v[80:95], v[184:187], a[52:55], v[80:95]
    s_waitcnt vmcnt(12)
    v_mfma_f32_32x32x16_bf16 v[64:79], v[188:191], a[56:59], v[64:79]
    buffer_load_dwordx4 v[164:167], v3, s[28:31], s71 offen sc1
    s_add_u32 s71, s71, 32768
    v_mfma_f32_32x32x16_bf16 v[80:95], v[188:191], a[60:63], v[80:95]
    s_waitcnt vmcnt(12)
    v_mfma_f32_32x32x16_bf16 v[64:79], v[192:195], a[64:67], v[64:79]
    buffer_load_dwordx4 v[168:171], v27, s[28:31], s71 offen sc1
    v_mfma_f32_32x32x16_bf16 v[80:95], v[192:195], a[68:71], v[80:95]
    s_waitcnt vmcnt(12)
    v_mfma_f32_32x32x16_bf16 v[64:79], v[196:199], a[72:75], v[64:79]
    buffer_load_dwordx4 v[172:175], v3, s[28:31], s71 offen sc1
    s_add_u32 s71, s71, 32768
    s_cmp_eq_u32 s71, s75
    s_cselect_b32 s71, s74, s71
    s_xor_b32 s71, s71, 1024
    s_xor_b32 s74, s74, 1024
    s_xor_b32 s75, s75, 1024
    v_mfma_f32_32x32x16_bf16 v[80:95], v[196:199], a[76:79], v[80:95]
    s_waitcnt vmcnt(12) lgkmcnt(14)
    v_mfma_f32_32x32x16_bf16 v[64:79], v[200:203], a[80:83], v[64:79]
    s_waitcnt vmcnt(9)
    v_cmp_ne_u64 vcc, s[26:27], v[30:31]
    s_nop 0
    s_cbranch_vccz L_ok4
    s_mov_b32 s77, 0
L_spin4:
    s_sleep 1
    buffer_load_dwordx2 v[30:31], v26, s[28:31], 0 offen sc1
    s_add_u32 s77, s77, 1
    s_cmp_ge_u32 s77, 0x10000
    s_waitcnt vmcnt(0)
    s_cbranch_scc1 L_ok4
    v_cmp_ne_u64 vcc, s[26:27], v[30:31]
    s_nop 0
    s_cbranch_vccnz L_spin4
L_ok4:
    buffer_load_dwordx4 a[176:179], v27, s[28:31], s73 offen offset:0 sc1
    v_mfma_f32_32x32x16_bf16 v[80:95], v[200:203], a[84:87], v[80:95]
    v_mfma_f32_32x32x16_bf16 v[64:79], v[204:207], a[88:91], v[64:79]
    buffer_load_dwordx4 a[180:183], v27, s[28:31], s73 offen offset:1024 sc1
    v_mfma_f32_32x32x16_bf16 v[80:95], v[204:207], a[92:95], v[80:95]
    v_mfma_f32_32x32x16_bf16 v[64:79], v[208:211], a[96:99], v[64:79]
    buffer_load_dwordx4 a[184:187], v27, s[28:31], s73 offen offset:2048 sc1
    v_mfma_f32_32x32x16_bf16 v[80:95], v[208:211], a[100:103], v[80:95]
    s_waitcnt vmcnt(11)
    v_mfma_f32_32x32x16_bf16 v[64:79], v[212:215], a[104:107], v[64:79]
    buffer_load_dwordx4 a[188:191], v27, s[28:31], s73 offen offset:3072 sc1
    s_add_u32 s73, s73, 4096
    v_mfma_f32_32x32x16_bf16 v[80:95], v[212:215], a[108:111], v[80:95]
    s_waitcnt vmcnt(11)
    v_mfma_f32_32x32x16_bf16 v[64:79], v[216:219], a[112:115], v[64:79]
    buffer_load_dwordx4 a[192:195], v27, s[28:31], s73 offen offset:0 sc1
    v_mfma_f32_32x32x16_bf16 v[80:95], v[216:219], a[116:119], v[80:95]
    s_waitcnt vmcnt(11)
    v_mfma_f32_32x32x16_bf16 v[64:79], v[220:223], a[120:123], v[64:79]
    buffer_load_dwordx4 a[196:199], v27, s[28:31], s73 offen offset:1024 sc1
    v_mfma_f32_32x32x16_bf16 v[80:95], v[220:223], a[124:127], v[80:95]
    s_waitcnt vmcnt(11)
    v_mfma_f32_32x32x16_bf16 v[64:79], v[224:227], a[128:131], v[64:79]
    buffer_load_dwordx4 a[200:203], v27, s[28:31], s73 offen offset:2048 sc1
    v_mfma_f32_32x32x16_bf16 v[80:95], v[224:227], a[132:135], v[80:95]
    s_waitcnt vmcnt(11)
    v_mfma_f32_32x32x16_bf16 v[64:79], v[228:231], a[136:139], v[64:79]
    buffer_load_dwordx4 a[204:207], v27, s[28:31], s73 offen offset:3072 sc1
    s_add_u32 s73, s73, 4096
    v_mfma_f32_32x32x16_bf16 v[80:95], v[228:231], a[140:143], v[80:95]
    s_waitcnt vmcnt(11)
    v_mfma_f32_32x32x16_bf16 v[64:79], v[160:163], a[144:147], v[64:79]
    buffer_load_dwordx4 a[208:211], v27, s[28:31], s73 offen offset:0 sc1
    s_waitcnt lgkmcnt(12)
    v_mfma_f32_32x32x16_bf16 v[80:95], v[160:163], a[148:151], v[80:95]
    s_waitcnt lgkmcnt(0)
    s_barrier
    s_waitcnt vmcnt(11)
    v_mfma_f32_32x32x16_bf16 v[64:79], v[164:167], a[152:155], v[64:79]
    buffer_load_dwordx4 a[212:215], v27, s[28:31], s73 offen offset:1024 sc1
    v_mfma_f32_32x32x16_bf16 v[80:95], v[164:167], a[156:159], v[80:95]
    s_waitcnt vmcnt(11)
    v_mfma_f32_32x32x16_bf16 v[64:79], v[168:171], a[160:163], v[64:79]
    buffer_load_dwordx4 a[216:219], v27, s[28:31], s73 offen offset:2048 sc1
    ds_read_b64_tr_b16 v[128:129], v12 offset:0
    ds_read_b64_tr_b16 v[130:131], v12 offset:1024
    v_mfma_f32_32x32x16_bf16 v[80:95], v[168:171], a[164:167], v[80:95]
    ds_read_b64_tr_b16 v[132:133], v13 offset:0
    ds_read_b64_tr_b16 v[134:135], v13 offset:1024
    s_waitcnt vmcnt(11)
    v_mfma_f32_32x32x16_bf16 v[64:79], v[172:175], a[168:171], v[64:79]
    buffer_load_dwordx4 a[220:223], v27, s[28:31], s73 offen offset:3072 sc1
    s_add_u32 s73, s73, 4096
    ds_read_b64_tr_b16 v[136:137], v12 offset:2048
    ds_read_b64_tr_b16 v[138:139], v12 offset:3072
    v_mfma_f32_32x32x16_bf16 v[80:95], v[172:175], a[172:175], v[80:95]
    ds_read_b64_tr_b16 v[140:141], v13 offset:2048
    ds_read_b64_tr_b16 v[142:143], v13 offset:3072
    s_waitcnt vmcnt(11) lgkmcnt(6)
    v_mfma_f32_32x32x16_bf16 v[96:111], v[128:131], a[176:179], 0
    buffer_load_dwordx4 a[224:227], v27, s[28:31], s73 offen offset:0 sc1
    ds_read_b64_tr_b16 v[144:145], v12 offset:4096
    ds_read_b64_tr_b16 v[146:147], v12 offset:5120
    s_waitcnt lgkmcnt(6)
    v_mfma_f32_32x32x16_bf16 v[112:127], v[132:135], a[176:179], 0
    ds_read_b64_tr_b16 v[148:149], v13 offset:4096
    ds_read_b64_tr_b16 v[150:151], v13 offset:5120
    s_waitcnt vmcnt(11) lgkmcnt(6)
    v_mfma_f32_32x32x16_bf16 v[96:111], v[136:139], a[180:183], v[96:111]
    buffer_load_dwordx4 a[228:231], v27, s[28:31], s73 offen offset:1024 sc1
    ds_read_b64_tr_b16 v[152:153], v12 offset:6144
    ds_read_b64_tr_b16 v[154:155], v12 offset:7168
    s_waitcnt lgkmcnt(6)
    v_mfma_f32_32x32x16_bf16 v[112:127], v[140:143], a[180:183], v[112:127]
    ds_read_b64_tr_b16 v[156:157], v13 offset:6144
    ds_read_b64_tr_b16 v[158:159], v13 offset:7168
    ds_write_b128 v18, v[64:67] offset:0
    s_waitcnt vmcnt(11) lgkmcnt(7)
    v_mfma_f32_32x32x16_bf16 v[96:111], v[144:147], a[184:187], v[96:111]
    buffer_load_dwordx4 a[232:235], v27, s[28:31], s73 offen offset:2048 sc1
    ds_read_b64_tr_b16 v[128:129], v12 offset:8192
    ds_read_b64_tr_b16 v[130:131], v12 offset:9216
    s_waitcnt lgkmcnt(7)
    v_mfma_f32_32x32x16_bf16 v[112:127], v[148:151], a[184:187], v[112:127]
    ds_read_b64_tr_b16 v[132:133], v13 offset:8192
    ds_read_b64_tr_b16 v[134:135], v13 offset:9216
    s_waitcnt vmcnt(11) lgkmcnt(7)
    v_mfma_f32_32x32x16_bf16 v[96:111], v[152:155], a[188:191], v[96:111]
    buffer_load_dwordx4 a[236:239], v27, s[28:31], s73 offen offset:3072 sc1
    ds_read_b64_tr_b16 v[136:137], v12 offset:10240
    ds_read_b64_tr_b16 v[138:139], v12 offset:11264
    s_waitcnt lgkmcnt(7)
    v_mfma_f32_32x32x16_bf16 v[112:127], v[156:159], a[188:191], v[112:127]
    ds_read_b64_tr_b16 v[140:141], v13 offset:10240
    ds_read_b64_tr_b16 v[142:143], v13 offset:11264
    ds_write_b128 v19, v[68:71] offset:0
    s_waitcnt vmcnt(11) lgkmcnt(7)
    v_mfma_f32_32x32x16_bf16 v[96:111], v[128:131], a[192:195], v[96:111]
    buffer_load_dwordx4 v[176:179], v27, s[28:31], s71 offen sc1
    ds_read_b64_tr_b16 v[144:145], v12 offset:12288
    ds_read_b64_tr_b16 v[146:147], v12 offset:13312
    s_waitcnt lgkmcnt(7)
    v_mfma_f32_32x32x16_bf16 v[112:127], v[132:135], a[192:195], v[112:127]
    ds_read_b64_tr_b16 v[148:149], v13 offset:12288
    ds_read_b64_tr_b16 v[150:151], v13 offset:13312
    s_waitcnt vmcnt(11) lgkmcnt(7)
    v_mfma_f32_32x32x16_bf16 v[96:111], v[136:139], a[196:199], v[96:111]
    buffer_load_dwordx4 v[180:183], v3, s[28:31], s71 offen sc1
    s_add_u32 s71, s71, 32768
    ds_read_b64_tr_b16 v[152:153], v12 offset:14336
    ds_read_b64_tr_b16 v[154:155], v12 offset:15360
    s_waitcnt lgkmcnt(7)
    v_mfma_f32_32x32x16_bf16 v[112:127], v[140:143], a[196:199], v[112:127]
    ds_read_b64_tr_b16 v[156:157], v13 offset:14336
    ds_read_b64_tr_b16 v[158:159], v13 offset:15360
    ds_write_b128 v20, v[72:75] offset:0
    s_waitcnt vmcnt(11) lgkmcnt(7)
    v_mfma_f32_32x32x16_bf16 v[96:111], v[144:147], a[200:203], v[96:111]
    buffer_load_dwordx4 v[184:187], v27, s[28:31], s71 offen sc1
    ds_read_b64_tr_b16 v[128:129], v12 offset:40960
    ds_read_b64_tr_b16 v[130:131], v12 offset:41984
    s_waitcnt lgkmcnt(7)
    v_mfma_f32_32x32x16_bf16 v[112:127], v[148:151], a[200:203], v[112:127]
    ds_read_b64_tr_b16 v[132:133], v13 offset:40960
    ds_read_b64_tr_b16 v[134:135], v13 offset:41984
    s_waitcnt vmcnt(11) lgkmcnt(7)
    v_mfma_f32_32x32x16_bf16 v[96:111], v[152:155], a[204:207], v[96:111]
    buffer_load_dwordx4 v[188:191], v3, s[28:31], s71 offen sc1
    s_add_u32 s71, s71, 32768
    s_cmp_eq_u32 s71, s75
    s_cselect_b32 s71, s74, s71
    ds_read_b64_tr_b16 v[136:137], v12 offset:43008
    ds_read_b64_tr_b16 v[138:139], v12 offset:44032
    s_waitcnt lgkmcnt(7)
    v_mfma_f32_32x32x16_bf16 v[112:127], v[156:159], a[204:207], v[112:127]
    ds_read_b64_tr_b16 v[140:141], v13 offset:43008
    ds_read_b64_tr_b16 v[142:143], v13 offset:44032
    ds_write_b128 v21, v[76:79] offset:0
    s_waitcnt vmcnt(11) lgkmcnt(7)
    v_mfma_f32_32x32x16_bf16 v[96:111], v[128:131], a[208:211], v[96:111]
    buffer_load_dwordx4 v[192:195], v27, s[28:31], s71 offen sc1
    ds_read_b64_tr_b16 v[144:145], v12 offset:45056
    ds_read_b64_tr_b16 v[146:147], v12 offset:46080
    s_waitcnt lgkmcnt(7)
    v_mfma_f32_32x32x16_bf16 v[112:127], v[132:135], a[208:211], v[112:127]
    ds_read_b64_tr_b16 v[148:149], v13 offset:45056
    ds_read_b64_tr_b16 v[150:151], v13 offset:46080
    s_waitcnt vmcnt(11) lgkmcnt(7)
    v_mfma_f32_32x32x16_bf16 v[96:111], v[136:139], a[212:215], v[96:111]
    buffer_load_dwordx4 v[196:199], v3, s[28:31], s71 offen sc1
    s_add_u32 s71, s71, 32768
    ds_read_b64_tr_b16 v[152:153], v12 offset:47104
    ds_read_b64_tr_b16 v[154:155], v12 offset:48128
    s_waitcnt lgkmcnt(7)
    v_mfma_f32_32x32x16_bf16 v[112:127], v[140:143], a[212:215], v[112:127]
    ds_read_b64_tr_b16 v[156:157], v13 offset:47104
    ds_read_b64_tr_b16 v[158:159], v13 offset:48128
    ds_write_b128 v18, v[80:83] offset:8192
    s_waitcnt vmcnt(11) lgkmcnt(7)
    v_mfma_f32_32x32x16_bf16 v[96:111], v[144:147], a[216:219], v[96:111]
    buffer_load_dwordx4 v[200:203], v27, s[28:31], s71 offen sc1
    ds_read_b64_tr_b16 v[128:129], v12 offset:49152
    ds_read_b64_tr_b16 v[130:131], v12 offset:50176
    s_waitcnt lgkmcnt(7)
    v_mfma_f32_32x32x16_bf16 v[112:127], v[148:151], a[216:219], v[112:127]
    ds_read_b64_tr_b16 v[132:133], v13 offset:49152
    ds_read_b64_tr_b16 v[134:135], v13 offset:50176
    s_waitcnt vmcnt(11) lgkmcnt(7)
    v_mfma_f32_32x32x16_bf16 v[96:111], v[152:155], a[220:223], v[96:111]
    buffer_load_dwordx4 v[204:207], v3, s[28:31], s71 offen sc1
    s_add_u32 s71, s71, 32768
    ds_read_b64_tr_b16 v[136:137], v12 offset:51200
    ds_read_b64_tr_b16 v[138:139], v12 offset:52224
    s_waitcnt lgkmcnt(7)
    v_mfma_f32_32x32x16_bf16 v[112:127], v[156:159], a[220:223], v[112:127]
    ds_read_b64_tr_b16 v[140:141], v13 offset:51200
    ds_read_b64_tr_b16 v[142:143], v13 offset:52224
    ds_write_b128 v19, v[84:87] offset:8192
    s_waitcnt vmcnt(11) lgkmcnt(7)
    v_mfma_f32_32x32x16_bf16 v[96:111], v[128:131], a[224:227], v[96:111]
    buffer_load_dwordx4 v[208:211], v27, s[28:31], s71 offen sc1
    ds_read_b64_tr_b16 v[144:145], v12 offset:53248
    ds_read_b64_tr_b16 v[146:147], v12 offset:54272
    s_waitcnt lgkmcnt(7)
    v_mfma_f32_32x32x16_bf16 v[112:127], v[132:135], a[224:227], v[112:127]
    ds_read_b64_tr_b16 v[148:149], v13 offset:53248
    ds_read_b64_tr_b16 v[150:151], v13 offset:54272
    s_waitcnt vmcnt(11) lgkmcnt(7)
    v_mfma_f32_32x32x16_bf16 v[96:111], v[136:139], a[228:231], v[96:111]
    buffer_load_dwordx4 v[212:215], v3, s[28:31], s71 offen sc1
    s_add_u32 s71, s71, 32768
    s_cmp_eq_u32 s71, s75
    s_cselect_b32 s71, s74, s71
    ds_read_b64_tr_b16 v[152:153], v12 offset:55296
    ds_read_b64_tr_b16 v[154:155], v12 offset:56320
    s_waitcnt lgkmcnt(7)
    v_mfma_f32_32x32x16_bf16 v[112:127], v[140:143], a[228:231], v[112:127]
    ds_read_b64_tr_b16 v[156:157], v13 offset:55296
    ds_read_b64_tr_b16 v[158:159], v13 offset:56320
    ds_write_b128 v20, v[88:91] offset:8192
    s_waitcnt vmcnt(11) lgkmcnt(7)
    v_mfma_f32_32x32x16_bf16 v[96:111], v[144:147], a[232:235], v[96:111]
    buffer_load_dwordx4 v[216:219], v27, s[28:31], s71 offen sc1
    s_waitcnt lgkmcnt(5)
    v_mfma_f32_32x32x16_bf16 v[112:127], v[148:151], a[232:235], v[112:127]
    s_waitcnt vmcnt(11) lgkmcnt(3)
    v_mfma_f32_32x32x16_bf16 v[96:111], v[152:155], a[236:239], v[96:111]
    buffer_load_dwordx4 v[220:223], v3, s[28:31], s71 offen sc1
    s_add_u32 s71, s71, 32768
    s_waitcnt lgkmcnt(1)
    v_mfma_f32_32x32x16_bf16 v[112:127], v[156:159], a[236:239], v[112:127]
    ds_write_b128 v21, v[92:95] offset:8192
    s_waitcnt vmcnt(11)
    v_mfma_f32_32x32x16_bf16 v[32:47], v[176:179], a[0:3], 0
    buffer_load_dwordx4 v[224:227], v27, s[28:31], s71 offen sc1
    v_mfma_f32_32x32x16_bf16 v[48:63], v[176:179], a[4:7], 0
    s_waitcnt vmcnt(11)
    v_mfma_f32_32x32x16_bf16 v[32:47], v[180:183], a[8:11], v[32:47]
    buffer_load_dwordx4 v[228:231], v3, s[28:31], s71 offen sc1
    s_add_u32 s71, s71, 32768
    ds_write_b128 v14, v[96:99] offset:16384
    v_lshlrev_b32 v128, 16, v248
    v_mfma_f32_32x32x16_bf16 v[48:63], v[180:183], a[12:15], v[48:63]
    v_and_b32 v129, 0xffff0000, v248
    ds_write_b128 v15, v[100:103] offset:16384
    s_waitcnt vmcnt(11)
    v_mfma_f32_32x32x16_bf16 v[32:47], v[184:187], a[16:19], v[32:47]
    buffer_load_dwordx4 v[160:163], v27, s[28:31], s71 offen sc1
    v_lshlrev_b32 v130, 16, v249
    v_and_b32 v131, 0xffff0000, v249
    v_mfma_f32_32x32x16_bf16 v[48:63], v[184:187], a[20:23], v[48:63]
    ds_write_b128 v16, v[104:107] offset:16384
    v_lshlrev_b32 v132, 16, v250
    s_waitcnt vmcnt(11)
    v_mfma_f32_32x32x16_bf16 v[32:47], v[188:191], a[24:27], v[32:47]
    buffer_load_dwordx4 v[164:167], v3, s[28:31], s71 offen sc1
    s_add_u32 s71, s71, 32768
    s_cmp_eq_u32 s71, s75
    s_cselect_b32 s71, s74, s71
    v_and_b32 v133, 0xffff0000, v250
    ds_write_b128 v17, v[108:111] offset:16384
    v_mfma_f32_32x32x16_bf16 v[48:63], v[188:191], a[28:31], v[48:63]
    v_lshlrev_b32 v134, 16, v251
    v_and_b32 v135, 0xffff0000, v251
    s_waitcnt vmcnt(11)
    v_mfma_f32_32x32x16_bf16 v[32:47], v[192:195], a[32:35], v[32:47]
    buffer_load_dwordx4 v[168:171], v27, s[28:31], s71 offen sc1
    ds_write_b128 v18, v[112:115] offset:16384
    v_lshlrev_b32 v136, 16, v252
    v_mfma_f32_32x32x16_bf16 v[48:63], v[192:195], a[36:39], v[48:63]
    v_and_b32 v137, 0xffff0000, v252
    ds_write_b128 v19, v[116:119] offset:16384
    s_waitcnt vmcnt(11)
    v_mfma_f32_32x32x16_bf16 v[32:47], v[196:199], a[40:43], v[32:47]
    buffer_load_dwordx4 v[172:175], v3, s[28:31], s71 offen sc1
    s_add_u32 s71, s71, 32768
    v_lshlrev_b32 v138, 16, v253
    v_and_b32 v139, 0xffff0000, v253
    v_mfma_f32_32x32x16_bf16 v[48:63], v[196:199], a[44:47], v[48:63]
    ds_write_b128 v20, v[120:123] offset:16384
    v_lshlrev_b32 v140, 16, v254
    s_waitcnt vmcnt(11)
    v_mfma_f32_32x32x16_bf16 v[32:47], v[200:203], a[48:51], v[32:47]
    buffer_load_dwordx4 v[176:179], v27, s[28:31], s71 offen sc1
    v_and_b32 v141, 0xffff0000, v254
    ds_write_b128 v21, v[124:127] offset:16384
    v_mfma_f32_32x32x16_bf16 v[48:63], v[200:203], a[52:55], v[48:63]
    v_lshlrev_b32 v142, 16, v255
    v_and_b32 v143, 0xffff0000, v255
    s_waitcnt lgkmcnt(0)
    s_barrier
    s_waitcnt vmcnt(11)
    v_mfma_f32_32x32x16_bf16 v[32:47], v[204:207], a[56:59], v[32:47]
    buffer_load_dwordx4 v[180:183], v3, s[28:31], s71 offen sc1
    s_add_u32 s71, s71, 32768
    ds_read_b128 v[64:67], v6 offset:0
    ds_read_b128 v[68:71], v6 offset:4096
    ds_read_b128 v[72:75], v6 offset:40960
    ds_read_b128 v[76:79], v6 offset:45056
    v_mfma_f32_32x32x16_bf16 v[48:63], v[204:207], a[60:63], v[48:63]
    ds_read_b128 v[80:83], v7 offset:0
    ds_read_b128 v[84:87], v7 offset:4096
    ds_read_b128 v[88:91], v7 offset:40960
    ds_read_b128 v[92:95], v7 offset:45056
    s_waitcnt vmcnt(11)
    v_mfma_f32_32x32x16_bf16 v[32:47], v[208:211], a[64:67], v[32:47]
    buffer_load_dwordx4 v[184:187], v27, s[28:31], s71 offen sc1
    ds_read_b128 v[112:115], v24 offset:16384
    ds_read_b128 v[116:119], v24 offset:20480
    ds_read_b128 v[120:123], v25 offset:16384
    ds_read_b128 v[124:127], v25 offset:20480
    v_mfma_f32_32x32x16_bf16 v[48:63], v[208:211], a[68:71], v[48:63]
    ds_read_b128 v[96:99], v8 offset:16384
    ds_read_b128 v[100:103], v8 offset:20480
    ds_read_b128 v[104:107], v9 offset:16384
    ds_read_b128 v[108:111], v9 offset:20480
    s_waitcnt vmcnt(11)
    v_mfma_f32_32x32x16_bf16 v[32:47], v[212:215], a[72:75], v[32:47]
    buffer_load_dwordx4 v[188:191], v3, s[28:31], s71 offen sc1
    s_waitcnt lgkmcnt(13)
    v_add_f32 v64, v72, v64
    v_add_f32 v65, v73, v65
    v_add_f32 v66, v74, v66
    v_add_f32 v67, v75, v67
    v_mfma_f32_32x32x16_bf16 v[48:63], v[212:215], a[76:79], v[48:63]
    s_waitcnt lgkmcnt(12)
    v_add_f32 v68, v76, v68
    v_add_f32 v69, v77, v69
    v_add_f32 v70, v78, v70
    v_add_f32 v71, v79, v71
    s_waitcnt vmcnt(11)
    v_mfma_f32_32x32x16_bf16 v[32:47], v[216:219], a[80:83], v[32:47]
    s_mov_b64 s[48:49], s[22:23]
    s_mov_b32 s50, 0x100
    s_mov_b32 s51, 0x20000
    s_or_b32 s59, s55, s3
    s_cselect_b32 s59, 0x1000, 0
    v_mov_b32 v30, 1
    s_mov_b64 exec, 1
    buffer_atomic_add v30, off, s[48:51], s59 sc0 sc1
    s_mov_b64 exec, -1
    v_add_f32 v64, v2, v64
    v_add_f32 v65, v2, v65
    v_add_f32 v66, v2, v66
    v_add_f32 v67, v2, v67
    v_mfma_f32_32x32x16_bf16 v[48:63], v[216:219], a[84:87], v[48:63]
    v_add_f32 v68, v2, v68
    v_add_f32 v69, v2, v69
    v_add_f32 v70, v2, v70
    v_add_f32 v71, v2, v71
    s_waitcnt vmcnt(11)
    v_mfma_f32_32x32x16_bf16 v[32:47], v[220:223], a[88:91], v[32:47]
    s_waitcnt lgkmcnt(9)
    v_add_f32 v80, v88, v80
    v_add_f32 v81, v89, v81
    v_add_f32 v82, v90, v82
    v_add_f32 v83, v91, v83
    v_mfma_f32_32x32x16_bf16 v[48:63], v[220:223], a[92:95], v[48:63]
    s_waitcnt lgkmcnt(8)
    v_add_f32 v84, v92, v84
    v_add_f32 v85, v93, v85
    v_add_f32 v86, v94, v86
    v_add_f32 v87, v95, v87
    s_waitcnt vmcnt(10)
    v_mfma_f32_32x32x16_bf16 v[32:47], v[224:227], a[96:99], v[32:47]
    v_add_f32 v64, v80, v64
    v_add_f32 v65, v81, v65
    v_add_f32 v66, v82, v66
    v_add_f32 v67, v83, v67
    v_mfma_f32_32x32x16_bf16 v[48:63], v[224:227], a[100:103], v[48:63]
    v_add_f32 v68, v84, v68
    v_add_f32 v69, v85, v69
    v_add_f32 v70, v86, v70
    v_add_f32 v71, v87, v71
    s_waitcnt vmcnt(9)
    v_mfma_f32_32x32x16_bf16 v[32:47], v[228:231], a[104:107], v[32:47]
    v_mul_f32 v144, s60, v64
    v_mul_f32 v145, s60, v65
    v_mul_f32 v146, s60, v66
    v_mul_f32 v147, s60, v67
    v_mfma_f32_32x32x16_bf16 v[48:63], v[228:231], a[108:111], v[48:63]
    v_mul_f32 v148, s60, v68
    v_mul_f32 v149, s60, v69
    v_mul_f32 v150, s60, v70
    v_mul_f32 v151, s60, v71
    s_waitcnt vmcnt(8)
    v_mfma_f32_32x32x16_bf16 v[32:47], v[160:163], a[112:115], v[32:47]
    s_waitcnt lgkmcnt(5)
    v_add_f32 v240, v120, v112
    v_add_f32 v241, v121, v113
    v_add_f32 v242, v122, v114
    v_add_f32 v243, v123, v115
    v_mfma_f32_32x32x16_bf16 v[48:63], v[160:163], a[116:119], v[48:63]
    s_waitcnt lgkmcnt(4)
    v_add_f32 v244, v124, v116
    v_add_f32 v245, v125, v117
    v_add_f32 v246, v126, v118
    v_add_f32 v247, v127, v119
    s_waitcnt vmcnt(7)
    v_mfma_f32_32x32x16_bf16 v[32:47], v[164:167], a[120:123], v[32:47]
    s_waitcnt lgkmcnt(1)
    v_add_f32 v232, v104, v96
    v_add_f32 v233, v105, v97
    v_add_f32 v234, v106, v98
    v_add_f32 v235, v107, v99
    v_mfma_f32_32x32x16_bf16 v[48:63], v[164:167], a[124:127], v[48:63]
    s_waitcnt lgkmcnt(0)
    v_add_f32 v236, v108, v100
    v_add_f32 v237, v109, v101
    v_add_f32 v238, v110, v102
    v_add_f32 v239, v111, v103
    s_waitcnt vmcnt(6)
    v_mfma_f32_32x32x16_bf16 v[32:47], v[168:171], a[128:131], v[32:47]
    v_exp_f32 v144, v144
    v_exp_f32 v145, v145
    v_exp_f32 v146, v146
    v_exp_f32 v147, v147
    v_mfma_f32_32x32x16_bf16 v[48:63], v[168:171], a[132:135], v[48:63]
    v_exp_f32 v148, v148
    v_exp_f32 v149, v149
    v_exp_f32 v150, v150
    v_exp_f32 v151, v151
    s_waitcnt vmcnt(5)
    v_mfma_f32_32x32x16_bf16 v[48:63], v[172:175], a[140:143], v[48:63]
    v_add_f32 v144, 1.0, v144
    v_add_f32 v145, 1.0, v145
    v_add_f32 v146, 1.0, v146
    v_add_f32 v147, 1.0, v147
    s_waitcnt vmcnt(4)
    v_mfma_f32_32x32x16_bf16 v[48:63], v[176:179], a[148:151], v[48:63]
    v_add_f32 v148, 1.0, v148
    v_add_f32 v149, 1.0, v149
    v_add_f32 v150, 1.0, v150
    v_add_f32 v151, 1.0, v151
    s_waitcnt vmcnt(3)
    v_mfma_f32_32x32x16_bf16 v[48:63], v[180:183], a[156:159], v[48:63]
    v_rcp_f32 v144, v144
    v_rcp_f32 v145, v145
    v_rcp_f32 v146, v146
    s_waitcnt vmcnt(2)
    v_mfma_f32_32x32x16_bf16 v[48:63], v[184:187], a[164:167], v[48:63]
    v_rcp_f32 v147, v147
    v_rcp_f32 v148, v148
    v_rcp_f32 v149, v149
    v_rcp_f32 v150, v150
    s_waitcnt vmcnt(1)
    v_mfma_f32_32x32x16_bf16 v[48:63], v[188:191], a[172:175], v[48:63]
    v_rcp_f32 v151, v151
    v_mul_f32 v64, v144, v64
    v_mul_f32 v65, v145, v65
    v_mfma_f32_32x32x16_bf16 v[32:47], v[172:175], a[136:139], v[32:47]
    v_mul_f32 v66, v146, v66
    v_mul_f32 v67, v147, v67
    v_mul_f32 v68, v148, v68
    v_mul_f32 v69, v149, v69
    v_mfma_f32_32x32x16_bf16 v[32:47], v[176:179], a[144:147], v[32:47]
    v_mul_f32 v70, v150, v70
    v_mul_f32 v71, v151, v71
    v_fma_f32 v64, v64, v240, v136
    v_mfma_f32_32x32x16_bf16 v[32:47], v[180:183], a[152:155], v[32:47]
    ds_write_b128 v14, v[48:51] offset:8192
    ds_write_b128 v15, v[52:55] offset:8192
    v_mfma_f32_32x32x16_bf16 v[32:47], v[184:187], a[160:163], v[32:47]
    ds_write_b128 v16, v[56:59] offset:8192
    v_mfma_f32_32x32x16_bf16 v[32:47], v[188:191], a[168:171], v[32:47]
    ds_write_b128 v17, v[60:63] offset:8192
    v_fma_f32 v65, v65, v241, v137
    v_fma_f32 v66, v66, v242, v138
    v_fma_f32 v67, v67, v243, v139
    v_fma_f32 v68, v68, v244, v140
    v_fma_f32 v69, v69, v245, v141
    v_fma_f32 v70, v70, v246, v142
    v_fma_f32 v71, v71, v247, v143
    v_cvt_pk_bf16_f32 v252, v64, v65
    v_cvt_pk_bf16_f32 v253, v66, v67
    v_cvt_pk_bf16_f32 v254, v68, v69
    v_cvt_pk_bf16_f32 v255, v70, v71
    buffer_store_dwordx4 v[252:255], v22, s[32:35], s69 offen sc1
    ds_write_b128 v14, v[32:35] offset:0
    ds_write_b128 v15, v[36:39] offset:0
    ds_write_b128 v16, v[40:43] offset:0
    ds_write_b128 v17, v[44:47] offset:0
    s_waitcnt lgkmcnt(0)
    s_barrier
    ds_read_b128 v[32:35], v4 offset:0
    ds_read_b128 v[36:39], v4 offset:4096
    ds_read_b128 v[40:43], v4 offset:40960
    ds_read_b128 v[44:47], v4 offset:45056
    ds_read_b128 v[48:51], v5 offset:0
    ds_read_b128 v[52:55], v5 offset:4096
    ds_read_b128 v[56:59], v5 offset:40960
    ds_read_b128 v[60:63], v5 offset:45056
    s_waitcnt lgkmcnt(5)
    v_pk_add_f32 v[32:33], v[32:33], v[40:41]
    v_pk_add_f32 v[34:35], v[34:35], v[42:43]
    s_waitcnt lgkmcnt(4)
    v_pk_add_f32 v[36:37], v[36:37], v[44:45]
    v_pk_add_f32 v[38:39], v[38:39], v[46:47]
    v_pk_add_f32 v[32:33], v[32:33], v[2:3] op_sel_hi:[1,0]
    v_pk_add_f32 v[34:35], v[34:35], v[2:3] op_sel_hi:[1,0]
    v_pk_add_f32 v[36:37], v[36:37], v[2:3] op_sel_hi:[1,0]
    v_pk_add_f32 v[38:39], v[38:39], v[2:3] op_sel_hi:[1,0]
    s_waitcnt lgkmcnt(1)
    v_pk_add_f32 v[48:49], v[48:49], v[56:57]
    v_pk_add_f32 v[50:51], v[50:51], v[58:59]
    s_waitcnt lgkmcnt(0)
    v_pk_add_f32 v[52:53], v[52:53], v[60:61]
    v_pk_add_f32 v[54:55], v[54:55], v[62:63]
    v_pk_add_f32 v[32:33], v[32:33], v[48:49]
    v_pk_add_f32 v[34:35], v[34:35], v[50:51]
    v_pk_add_f32 v[36:37], v[36:37], v[52:53]
    v_pk_add_f32 v[38:39], v[38:39], v[54:55]
    v_pk_mul_f32 v[144:145], v[32:33], s[60:61] op_sel_hi:[1,0]
    v_pk_mul_f32 v[146:147], v[34:35], s[60:61] op_sel_hi:[1,0]
    v_pk_mul_f32 v[148:149], v[36:37], s[60:61] op_sel_hi:[1,0]
    v_pk_mul_f32 v[150:151], v[38:39], s[60:61] op_sel_hi:[1,0]
    v_exp_f32 v144, v144
    v_exp_f32 v145, v145
    v_exp_f32 v146, v146
    v_exp_f32 v147, v147
    v_exp_f32 v148, v148
    v_exp_f32 v149, v149
    v_exp_f32 v150, v150
    v_exp_f32 v151, v151
    v_pk_add_f32 v[144:145], v[144:145], 1.0 op_sel_hi:[1,0]
    v_pk_add_f32 v[146:147], v[146:147], 1.0 op_sel_hi:[1,0]
    v_pk_add_f32 v[148:149], v[148:149], 1.0 op_sel_hi:[1,0]
    v_pk_add_f32 v[150:151], v[150:151], 1.0 op_sel_hi:[1,0]
    v_rcp_f32 v144, v144
    v_rcp_f32 v145, v145
    v_rcp_f32 v146, v146
    v_rcp_f32 v147, v147
    v_rcp_f32 v148, v148
    v_rcp_f32 v149, v149
    v_rcp_f32 v150, v150
    v_rcp_f32 v151, v151
    v_pk_mul_f32 v[32:33], v[32:33], v[144:145]
    v_pk_mul_f32 v[34:35], v[34:35], v[146:147]
    v_pk_mul_f32 v[36:37], v[36:37], v[148:149]
    v_pk_mul_f32 v[38:39], v[38:39], v[150:151]
    v_pk_fma_f32 v[32:33], v[32:33], v[232:233], v[128:129]
    v_pk_fma_f32 v[34:35], v[34:35], v[234:235], v[130:131]
    v_pk_fma_f32 v[36:37], v[36:37], v[236:237], v[132:133]
    v_pk_fma_f32 v[38:39], v[38:39], v[238:239], v[134:135]
    v_cvt_pk_bf16_f32 v248, v32, v33
    v_cvt_pk_bf16_f32 v249, v34, v35
    v_cvt_pk_bf16_f32 v250, v36, v37
    v_cvt_pk_bf16_f32 v251, v38, v39
    buffer_store_dwordx4 v[248:251], v23, s[32:35], s69 offen sc1
    s_waitcnt vmcnt(2)
    v_readfirstlane_b32 s62, v30
    s_nop 0
    s_and_b32 s62, s62, 7
    s_or_b32 s62, s62, s59
    s_cmp_lg_u32 s62, 7
    s_cbranch_scc1 L_noepoch
    s_mov_b64 exec, 1
    buffer_store_dwordx2 v[28:29], off, s[28:31], s59 sc1
    s_mov_b64 exec, -1
L_noepoch:
L_end:
    s_endpgm
.section .rodata,"a"
.p2align 6
.amdhsa_kernel recurrent_scan__linear_attn_block__mixer_token_mlp__prompt_kernel
  .amdhsa_next_free_vgpr 512
  .amdhsa_next_free_sgpr 102
  .amdhsa_accum_offset 256
  .amdhsa_group_segment_fixed_size 0
  .amdhsa_kernarg_size 88
  .amdhsa_user_sgpr_count 2
  .amdhsa_user_sgpr_kernarg_segment_ptr 1
  .amdhsa_system_sgpr_workgroup_id_x 1
  .amdhsa_float_denorm_mode_32 3
.end_amdhsa_kernel
```
